```python
import torch

def _softmax(x, axis=-1):
    return torch.softmax(x, dim=axis)
def _gelu(x):
    return torch.nn.functional.gelu(x, approximate="tanh")
def _silu(x):
    return torch.nn.functional.silu(x)
def _sigmoid(x):
    return torch.sigmoid(x)
def _layernorm(x, axis=-1, eps=1e-5):
    m = x.mean(dim=axis, keepdim=True)
    v = x.var(dim=axis, keepdim=True, unbiased=False)
    return (x - m) / torch.sqrt(v + eps)
def _scatter_add(tgt, idx, src, axis=0):
    return tgt.clone().index_add_(axis, idx, src)
def _segment_sum(src, seg, n):
    out = torch.zeros((n,) + src.shape[1:], dtype=src.dtype)
    return out.index_add_(0, seg, src)
def _pad(x, pw):
    flat = tuple(v for pair in reversed(pw) for v in pair)
    return torch.nn.functional.pad(x, flat)

kernel_name = 'gated_mix__softmax_full_mha__sliding_local_dilated__prompt'

def setup_inputs():

    _w = (lambda a: (lambda t: t.to(torch.bfloat16) if t.is_floating_point() else t)(torch.as_tensor(a)))
    def _A_setup():
        B, S, D = 1, 2048, 1024
        return {
            "x": _w((lambda *s: torch.randn(*s, dtype=torch.bfloat16) * 0.05)(B, S, D)),
            "wqkv": _w((lambda *s: torch.randn(*s, dtype=torch.bfloat16) * 0.8)(D, 3 * D)),
            "wo": _w((lambda *s: torch.randn(*s, dtype=torch.bfloat16) * 0.1)(D, D)),
        }
    _A_in = _A_setup()

    def _B_setup():
        B, S, D = 1, 2048, 1024
        return {
            "x": _w((lambda *s: torch.randn(*s, dtype=torch.bfloat16) * 0.05)(B, S, D)),
            "wqkv": _w((lambda *s: torch.randn(*s, dtype=torch.bfloat16) * 0.8)(D, 3 * D)),
            "wo": _w((lambda *s: torch.randn(*s, dtype=torch.bfloat16) * 0.05)(D, D)),
        }
    _B_in = _B_setup()

    return {
        "A_x": _A_in["x"],
        "A_wqkv": _A_in["wqkv"],
        "A_wo": _A_in["wo"],
        "B_x": _B_in["x"],
        "B_wqkv": _B_in["wqkv"],
        "B_wo": _B_in["wo"],
        "gate_w": _w((lambda *s: torch.randn(*s, dtype=torch.bfloat16) * 0.05)(1024) * 16.0),
    }

def reference(A_x, A_wqkv, A_wo, B_x, B_wqkv, B_wo, gate_w):
    def _A_ref(x, wqkv, wo):
        B, S, D = x.shape
        H = 32; Dh = D // H
        qkv = (lambda x, *d: x.permute(*d))((x @ wqkv).reshape(B, S, 3, H, Dh), 2, 0, 3, 1, 4)
        q, k, v = qkv[0], qkv[1], qkv[2]
        scale = Dh ** -0.5
        scores = torch.einsum("bhqd,bhkd->bhqk", q, k) * scale
        p = _softmax(scores, axis=-1)
        o = torch.einsum("bhqk,bhkd->bhqd", p, v)
        return (lambda x, *d: x.permute(*d))(o, 0, 2, 1, 3).reshape(B, S, D) @ wo

    def _B_ref(x, wqkv, wo):
        B, S, D = x.shape
        H = 32; Dh = D // H
        W, dil = 8, 2
        qkv = (lambda x, *d: x.permute(*d))((x @ wqkv).reshape(B, S, 3, H, Dh), 2, 0, 3, 1, 4)
        q, k, v = qkv[0], qkv[1], qkv[2]
        scale = Dh ** -0.5
        pos = torch.arange(S)
        off = torch.arange(W) * dil
        idx = pos[:, None] - off[None, :]
        mask = idx >= 0
        idx_c = torch.where(mask, idx, 0).reshape(-1)
        kg = k[:, :, idx_c, :].reshape(B, H, S, W, Dh)
        vg = v[:, :, idx_c, :].reshape(B, H, S, W, Dh)
        logits = torch.einsum("bhsd,bhswd->bhsw", q, kg) * scale
        logits = torch.where(mask[None, None, :, :], logits, -1e9)
        attn = _softmax(logits, axis=-1)
        o = torch.einsum("bhsw,bhswd->bhsd", attn, vg)
        return (lambda x, *d: x.permute(*d))(o, 0, 2, 1, 3).reshape(B, S, D) @ wo

    x = A_x
    g = _sigmoid((x * gate_w).sum(-1, keepdims=True))
    a = _A_ref(x, A_wqkv, A_wo)
    b = _B_ref(x, B_wqkv, B_wo)
    return g * a + (1 - g) * b
```

```asm
; @launch grid=(256,1,1) block=(512,1,1) lds=163840
.amdgcn_target "amdgcn-amd-amdhsa--gfx950"
.text
.globl gated_mix__softmax_full_mha__sliding_local_dilated__prompt_kernel
.p2align 8
.type gated_mix__softmax_full_mha__sliding_local_dilated__prompt_kernel,@function
gated_mix__softmax_full_mha__sliding_local_dilated__prompt_kernel:
    s_cmp_ge_u32 s2, 256
    s_cbranch_scc1 Lend
    s_load_dwordx16 s[44:59], s[0:1], 0
    s_load_dwordx4 s[60:63], s[0:1], 64
    s_getpc_b64 s[26:27]
    v_lshlrev_b32 v14, 7, v0
    v_cmp_gt_u32 vcc, 184, v0
    s_and_saveexec_b64 s[28:29], vcc
    s_cbranch_execz Lcpf
    global_load_dword v15, v14, s[26:27]
Lcpf:
    s_mov_b64 exec, -1
    v_lshrrev_b32 v4, 6, v0
    v_and_b32 v0, 63, v0
    s_and_b32 s23, s2, 7
    v_readfirstlane_b32 s20, v4
    s_lshr_b32 s24, s2, 3
    s_and_b32 s21, s2, 3
    s_lshr_b32 s26, s2, 6
    s_lshl2_add_u32 s21, s21, s26
    s_bfe_u32 s22, s2, 0x10002
    s_and_b32 s27, s24, 7
    s_lshl3_add_u32 s22, s22, s27
    s_cmp_ge_u32 s20, 5
    s_cselect_b32 s25, 5, 2
    s_sub_u32 s25, s20, s25
    s_lshl4_add_u32 s25, s25, s21
    s_lshl_b32 s25, s25, 7
    s_mul_i32 s27, s27, 49152
    s_lshl1_add_u32 s28, s22, s20
    s_lshl_b32 s28, s28, 17
    s_lshl_b32 s26, s26, 15
    s_mov_b32 s31, 393216
    s_movk_i32 s32, 6144
    s_mov_b32 s10, 0x600000
    s_mov_b32 s11, 0x20000
    s_cmp_lt_u32 s20, 2
    s_cselect_b32 s29, s28, s25
    s_cselect_b32 s26, s26, s27
    s_cselect_b32 s31, 128, s31
    s_cselect_b32 s32, 2048, s32
    s_cselect_b32 s28, 15, 7
    s_cselect_b32 s10, 0x400000, s10
    v_cmp_lt_u32 vcc, s28, v0
    v_mul_u32_u24 v200, s32, v0
    v_bfrev_b32 v5, 2
    s_add_u32 s38, s26, s29
    v_cndmask_b32 v200, v200, v5, vcc
    s_cmp_ge_u32 s20, 5
    s_waitcnt lgkmcnt(0)
    s_cselect_b32 s8, s52, s46
    s_cselect_b32 s9, s53, s47
    s_cmp_lt_u32 s20, 2
    s_cselect_b32 s8, s44, s8
    s_cselect_b32 s9, s45, s9
    buffer_load_dword v201, v200, s[8:11], s38 offen
    s_add_u32 s38, s38, s31
    buffer_load_dword v201, v200, s[8:11], s38 offen
    s_add_u32 s38, s38, s31
    s_cmp_lt_u32 s20, 2
    s_cselect_b32 s26, 7, 2
    s_cselect_b32 s27, 0, 1
    s_movk_i32 s34, 8192
    s_cselect_b32 s34, 16384, s34
    s_movk_i32 s35, 16383
    s_cselect_b32 s35, 65535, s35
    s_cselect_b32 s25, 13, 14
    s_cselect_b32 s28, 0, 32768
    s_lshl_b32 s36, s20, s25
    s_add_u32 s36, s36, s28
    s_mov_b32 s33, 0
    v_lshrrev_b32 v4, 3, v0
    v_mul_u32_u24 v4, s32, v4
    v_lshrrev_b32 v5, 4, v0
    v_lshlrev_b32 v5, s27, v5
    v_and_b32 v5, s26, v5
    v_and_b32 v6, 7, v0
    v_xor_b32 v5, v5, v6
    v_lshl_add_u32 v192, v5, 4, v4
    v_xor_b32 v193, 64, v192
    s_lshl_b32 s25, s32, 3
    s_sub_u32 s26, s25, 1024
    s_lshl_b32 s27, s26, 1
    v_add_u32 v193, s26, v193
    v_add_u32 v194, s27, v192
    v_add_u32 v195, s27, v193
    s_lshl_b32 s27, s25, 2
    v_add_u32 v196, s27, v192
    v_add_u32 v197, s27, v193
    v_add_u32 v198, s27, v194
    v_add_u32 v199, s27, v195
    s_barrier
    s_add_u32 m0, s33, s36
    s_add_u32 s33, s33, s34
    buffer_load_dwordx4 v192, s[8:11], s29 offen offset:0  lds
    buffer_load_dwordx4 v193, s[8:11], s29 offen offset:1024  lds
    buffer_load_dwordx4 v194, s[8:11], s29 offen offset:2048  lds
    buffer_load_dwordx4 v195, s[8:11], s29 offen offset:3072  lds
    s_and_b32 s33, s33, s35
    s_add_u32 m0, m0, 4096
    s_nop 0
    buffer_load_dwordx4 v196, s[8:11], s29 offen offset:0  lds
    buffer_load_dwordx4 v197, s[8:11], s29 offen offset:1024  lds
    buffer_load_dwordx4 v198, s[8:11], s29 offen offset:2048  lds
    buffer_load_dwordx4 v199, s[8:11], s29 offen offset:3072  lds
    s_add_u32 s29, s29, s31
    s_barrier
    s_add_u32 m0, s33, s36
    s_add_u32 s33, s33, s34
    buffer_load_dwordx4 v192, s[8:11], s29 offen offset:0  lds
    buffer_load_dwordx4 v193, s[8:11], s29 offen offset:1024  lds
    buffer_load_dwordx4 v194, s[8:11], s29 offen offset:2048  lds
    buffer_load_dwordx4 v195, s[8:11], s29 offen offset:3072  lds
    s_and_b32 s33, s33, s35
    buffer_load_dword v201, v200, s[8:11], s38 offen
    s_add_u32 s38, s38, s31
    s_cmp_ge_u32 s20, 2
    s_cbranch_scc1 Lp1_x0
    s_add_u32 m0, m0, 4096
    s_nop 0
    buffer_load_dwordx4 v196, s[8:11], s29 offen offset:0  lds
    buffer_load_dwordx4 v197, s[8:11], s29 offen offset:1024  lds
    buffer_load_dwordx4 v198, s[8:11], s29 offen offset:2048  lds
    buffer_load_dwordx4 v199, s[8:11], s29 offen offset:3072  lds
    s_add_u32 s29, s29, s31
Lp1_x0:
    v_lshlrev_b32 v12, 4, v0
    s_and_b32 s41, s20, 1
    s_bfe_u32 s42, s20, 0x10001
    s_lshr_b32 s43, s20, 2
    s_mov_b32 s4, s44
    s_mov_b32 s5, s45
    s_mov_b32 s6, 0x400000
    s_mov_b32 s7, 0x20000
    s_mov_b32 s12, s62
    s_mov_b32 s13, s63
    s_mov_b32 s14, 33554432
    s_mov_b32 s15, 0x20000
    s_mov_b32 s16, s60
    s_mov_b32 s17, s61
    s_mov_b32 s18, 256
    s_mov_b32 s19, 0x20000
    v_and_b32 v4, 15, v0
    v_lshrrev_b32 v5, 4, v0
    v_lshrrev_b32 v6, 1, v4
    v_xor_b32 v6, v6, v5
    v_lshlrev_b32 v6, 4, v6
    v_lshl_add_u32 v203, v4, 7, v6
    s_lshl_b32 s25, s41, 13
    v_add_u32 v203, s25, v203
    v_xor_b32 v204, 64, v203
    v_lshrrev_b32 v6, 2, v4
    v_lshl_add_u32 v6, v5, 3, v6
    v_lshlrev_b32 v6, 7, v6
    v_bfe_u32 v7, v0, 3, 2
    s_lshl_b32 s25, s42, 1
    v_xor_b32 v7, s25, v7
    v_lshl_add_u32 v6, v7, 5, v6
    v_and_b32 v7, 3, v0
    v_lshl_add_u32 v6, v7, 3, v6
    s_mul_i32 s25, s43, 49152
    s_add_u32 s25, s25, 65536
    v_add_u32 v205, s25, v6
    v_xor_b32 v206, 32, v205
    s_mov_b32 s64, s54
    s_mov_b32 s65, s55
    s_mov_b32 s66, 0x200000
    s_mov_b32 s67, 0x20000
    s_cmp_ge_u32 s20, 2
    s_cbranch_scc1 Lp1_x1
    s_waitcnt vmcnt(9)
    s_branch Lp1_x2
Lp1_x1:
    s_waitcnt vmcnt(5)
Lp1_x2:
    s_barrier
    ds_read_b128 v[112:115], v203 offset:0
    ds_read_b64_tr_b16 v[128:129], v205 offset:0
    ds_read_b64_tr_b16 v[130:131], v205 offset:512
    ds_read_b64_tr_b16 v[132:133], v206 offset:0
    ds_read_b64_tr_b16 v[134:135], v206 offset:512
    ds_read_b128 v[116:119], v203 offset:2048
    ds_read_b64_tr_b16 v[136:137], v205 offset:16384
    ds_read_b64_tr_b16 v[138:139], v205 offset:16896
    ds_read_b64_tr_b16 v[140:141], v206 offset:16384
    ds_read_b64_tr_b16 v[142:143], v206 offset:16896
    ds_read_b128 v[120:123], v203 offset:4096
    ds_read_b64_tr_b16 v[144:145], v205 offset:32768
    ds_read_b64_tr_b16 v[146:147], v205 offset:33280
    ds_read_b64_tr_b16 v[148:149], v206 offset:32768
    ds_read_b64_tr_b16 v[150:151], v206 offset:33280
    ds_read_b128 v[124:127], v203 offset:6144
    s_or_b32 s25, s2, s20
    s_cmp_lg_u32 s25, 0
    s_cbranch_scc1 Lnon0
    s_mov_b32 s25, 19922944
    buffer_load_dword v13, off, s[12:15], s25 sc1
Lnon0:
    s_cmp_ge_u32 s20, 2
    s_cbranch_scc1 Lp1_w
    buffer_load_dword v201, v200, s[8:11], s38 offen
    s_add_u32 s38, s38, s31
    s_add_u32 m0, s33, s36
    s_add_u32 s33, s33, s34
    buffer_load_dwordx4 v192, s[8:11], s29 offen offset:0  lds
    buffer_load_dwordx4 v193, s[8:11], s29 offen offset:1024  lds
    buffer_load_dwordx4 v194, s[8:11], s29 offen offset:2048  lds
    buffer_load_dwordx4 v195, s[8:11], s29 offen offset:3072  lds
    s_and_b32 s33, s33, s35
    s_branch Lp1_w2
Lp1_w:
Lp1_w2:
    s_waitcnt lgkmcnt(0)
    s_setprio 3
    v_mfma_f32_16x16x32_bf16 v[16:19], v[128:131], v[112:115], 0
    ds_read_b128 v[152:155], v204 offset:0
    s_add_u32 m0, m0, 4096
    s_and_b32 s75, s24, 3
    s_lshl_b32 s75, s75, 2
    v_mfma_f32_16x16x32_bf16 v[20:23], v[132:135], v[112:115], 0
    ds_read_b64_tr_b16 v[168:169], v205 offset:4096
    s_and_b32 s26, s20, 3
    s_add_u32 s75, s75, s26
    v_mfma_f32_16x16x32_bf16 v[48:51], v[136:139], v[112:115], 0
    ds_read_b64_tr_b16 v[170:171], v205 offset:4608
    s_lshl_b32 s75, s75, 17
    s_and_b32 s26, s23, 1
    v_mfma_f32_16x16x32_bf16 v[52:55], v[140:143], v[112:115], 0
    ds_read_b64_tr_b16 v[172:173], v206 offset:4096
    buffer_load_dwordx4 v196, s[8:11], s29 offen offset:0  lds
    s_lshl_b32 s26, s26, 3
    s_lshr_b32 s27, s24, 2
    v_mfma_f32_16x16x32_bf16 v[80:83], v[112:115], v[144:147], 0
    ds_read_b64_tr_b16 v[174:175], v206 offset:4608
    s_add_u32 s26, s26, s27
    s_lshl_b32 s26, s26, 7
    v_mfma_f32_16x16x32_bf16 v[84:87], v[112:115], v[148:151], 0
    ds_read_b128 v[156:159], v204 offset:2048
    s_add_u32 s75, s75, s26
    v_lshlrev_b32 v202, 11, v0
    s_setprio 2
    v_mfma_f32_16x16x32_bf16 v[92:95], v[116:119], v[148:151], 0
    ds_read_b64_tr_b16 v[176:177], v205 offset:20480
    s_cmp_eq_u32 s43, 0
    s_cselect_b32 s75, 0x40000000, s75
    v_and_b32 v236, 15, v0
    v_mfma_f32_16x16x32_bf16 v[88:91], v[116:119], v[144:147], 0
    ds_read_b64_tr_b16 v[178:179], v205 offset:20992
    buffer_load_dwordx4 v197, s[8:11], s29 offen offset:1024  lds
    v_lshrrev_b32 v237, 4, v0
    v_mfma_f32_16x16x32_bf16 v[60:63], v[140:143], v[116:119], 0
    ds_read_b64_tr_b16 v[180:181], v206 offset:20480
    v_lshlrev_b32 v238, 9, v237
    v_lshrrev_b32 v8, 3, v236
    v_mfma_f32_16x16x32_bf16 v[56:59], v[136:139], v[116:119], 0
    ds_read_b64_tr_b16 v[182:183], v206 offset:20992
    v_and_b32 v10, 7, v0
    v_lshl_add_u32 v8, v8, 4, v10
    v_mfma_f32_16x16x32_bf16 v[28:31], v[132:135], v[116:119], 0
    ds_read_b128 v[160:163], v204 offset:4096
    v_lshl_add_u32 v239, v8, 4, v238
    v_lshl_add_u32 v238, v236, 4, v238
    v_mfma_f32_16x16x32_bf16 v[24:27], v[128:131], v[116:119], 0
    ds_read_b64_tr_b16 v[184:185], v205 offset:36864
    buffer_load_dwordx4 v198, s[8:11], s29 offen offset:2048  lds
    s_lshl_b32 s68, s21, 1
    s_add_u32 s68, s68, s42
    s_setprio 1
    v_mfma_f32_16x16x32_bf16 v[32:35], v[128:131], v[120:123], 0
    ds_read_b64_tr_b16 v[186:187], v205 offset:37376
    s_lshl_b32 s73, s21, 4
    s_add_u32 s73, s73, s22
    v_mfma_f32_16x16x32_bf16 v[36:39], v[132:135], v[120:123], 0
    ds_read_b64_tr_b16 v[188:189], v206 offset:36864
    s_lshl_b32 s99, s21, 6
    s_add_u32 s99, s99, s22
    v_mfma_f32_16x16x32_bf16 v[64:67], v[136:139], v[120:123], 0
    ds_read_b64_tr_b16 v[190:191], v206 offset:37376
    s_lshl_b32 s99, s99, 2
    s_add_u32 s99, s99, 19922944
    v_mfma_f32_16x16x32_bf16 v[68:71], v[140:143], v[120:123], 0
    ds_read_b128 v[164:167], v204 offset:6144
    buffer_load_dwordx4 v199, s[8:11], s29 offen offset:3072  lds
    s_lshl_b32 s100, s22, 6
    v_mfma_f32_16x16x32_bf16 v[96:99], v[120:123], v[144:147], 0
    s_add_u32 s100, s100, s21
    s_lshl_b32 s100, s100, 2
    v_mfma_f32_16x16x32_bf16 v[100:103], v[120:123], v[148:151], 0
    s_add_u32 s100, s100, 19927040
    s_lshl_b32 s72, s68, 5
    s_setprio 0
    v_mfma_f32_16x16x32_bf16 v[108:111], v[124:127], v[148:151], 0
    s_lshl_b32 s26, s22, 1
    s_add_u32 s72, s72, s26
    v_mfma_f32_16x16x32_bf16 v[104:107], v[124:127], v[144:147], 0
    buffer_load_dword v201, v200, s[8:11], s38 offen
    s_add_u32 s72, s72, s41
    s_lshl_b32 s30, s68, 1
    v_mfma_f32_16x16x32_bf16 v[76:79], v[140:143], v[124:127], 0
    s_add_u32 s38, s38, s31
    s_add_u32 s30, s30, s41
    s_lshl_b32 s30, s30, 4
    v_mfma_f32_16x16x32_bf16 v[72:75], v[136:139], v[124:127], 0
    s_add_u32 s29, s29, s31
    s_add_u32 s30, s30, s22
    s_lshl_b32 s30, s30, 13
    v_mfma_f32_16x16x32_bf16 v[44:47], v[132:135], v[124:127], 0
    s_add_u32 s30, s30, 8388608
    v_mfma_f32_16x16x32_bf16 v[40:43], v[128:131], v[124:127], 0
    s_waitcnt vmcnt(6) lgkmcnt(0)
    s_barrier
    s_setprio 3
    v_mfma_f32_16x16x32_bf16 v[16:19], v[168:171], v[152:155], v[16:19]
    ds_read_b128 v[112:115], v203 offset:16384
    s_add_u32 m0, s33, s36
    s_add_u32 s69, s30, 4096
    s_lshl_b32 s72, s72, 12
    v_mfma_f32_16x16x32_bf16 v[20:23], v[172:175], v[152:155], v[20:23]
    ds_read_b64_tr_b16 v[128:129], v205 offset:8192
    s_add_u32 s33, s33, s34
    s_add_u32 s72, s72, 0
    s_lshl_b32 s26, s22, 4
    v_mfma_f32_16x16x32_bf16 v[48:51], v[176:179], v[152:155], v[48:51]
    ds_read_b64_tr_b16 v[130:131], v205 offset:8704
    s_add_u32 s26, s26, s21
    s_lshl_b32 s26, s26, 2
    v_mfma_f32_16x16x32_bf16 v[52:55], v[180:183], v[152:155], v[52:55]
    ds_read_b64_tr_b16 v[132:133], v206 offset:8192
    buffer_load_dwordx4 v192, s[8:11], s29 offen offset:0  lds
    s_add_u32 s26, s26, s20
    s_lshl_b32 s27, s73, 1
    v_mfma_f32_16x16x32_bf16 v[80:83], v[152:155], v[184:187], v[80:83]
    ds_read_b64_tr_b16 v[134:135], v206 offset:8704
    s_add_u32 s27, s27, s42
    s_lshl_b32 s28, s27, 6
    v_mfma_f32_16x16x32_bf16 v[84:87], v[152:155], v[188:191], v[84:87]
    ds_read_b128 v[116:119], v203 offset:18432
    s_add_u32 s28, s28, 19931136
    s_lshl_b32 s27, s27, 11
    s_setprio 2
    v_mfma_f32_16x16x32_bf16 v[92:95], v[156:159], v[188:191], v[92:95]
    ds_read_b64_tr_b16 v[136:137], v205 offset:24576
    s_add_u32 s27, s27, 16777216
    s_cmp_eq_u32 s43, 0
    s_cselect_b32 s25, s26, s27
    s_cselect_b32 s47, s26, s28
    v_mfma_f32_16x16x32_bf16 v[88:91], v[156:159], v[184:187], v[88:91]
    ds_read_b64_tr_b16 v[138:139], v205 offset:25088
    buffer_load_dwordx4 v193, s[8:11], s29 offen offset:1024  lds
    v_bfe_u32 v8, v0, 2, 1
    v_mfma_f32_16x16x32_bf16 v[60:63], v[180:183], v[156:159], v[60:63]
    ds_read_b64_tr_b16 v[140:141], v206 offset:24576
    v_bfe_i32 v9, v0, 1, 1
    v_not_b32 v9, v9
    v_mfma_f32_16x16x32_bf16 v[56:59], v[176:179], v[156:159], v[56:59]
    ds_read_b64_tr_b16 v[142:143], v206 offset:25088
    v_and_b32 v9, 0x3f803f80, v9
    v_and_b32 v11, 1, v0
    v_mfma_f32_16x16x32_bf16 v[28:31], v[172:175], v[156:159], v[28:31]
    ds_read_b128 v[120:123], v203 offset:20480
    v_cmp_eq_u32 vcc, 0, v8
    v_mov_b32 v248, 0xeeeeeeee
    v_mov_b32 v8, 0x44444444
    v_cndmask_b32 v244, 0, v9, vcc
    v_cmp_eq_u32 vcc, 0, v11
    v_mov_b32 v245, v244
    v_xor_b32 v246, v9, v244
    v_cndmask_b32 v248, v248, v8, vcc
    v_mfma_f32_16x16x32_bf16 v[24:27], v[168:171], v[156:159], v[24:27]
    ds_read_b64_tr_b16 v[144:145], v205 offset:40960
    buffer_load_dwordx4 v194, s[8:11], s29 offen offset:2048  lds
    v_mov_b32 v247, v246
    v_lshrrev_b32 v8, 3, v0
    s_setprio 1
    v_mfma_f32_16x16x32_bf16 v[32:35], v[168:171], v[160:163], v[32:35]
    ds_read_b64_tr_b16 v[146:147], v205 offset:41472
    v_lshlrev_b32 v11, 11, v8
    v_lshlrev_b32 v9, 1, v237
    v_mfma_f32_16x16x32_bf16 v[36:39], v[172:175], v[160:163], v[36:39]
    ds_read_b64_tr_b16 v[148:149], v206 offset:40960
    v_xor_b32 v9, v9, v10
    v_lshl_add_u32 v252, v9, 4, v11
    v_mfma_f32_16x16x32_bf16 v[64:67], v[176:179], v[160:163], v[64:67]
    ds_read_b64_tr_b16 v[150:151], v206 offset:41472
    v_add_u32 v253, 15360, v252
    v_add_u32 v254, 30720, v252
    v_mfma_f32_16x16x32_bf16 v[68:71], v[180:183], v[160:163], v[68:71]
    ds_read_b128 v[124:127], v203 offset:22528
    buffer_load_dwordx4 v195, s[8:11], s29 offen offset:3072  lds
    v_add_u32 v255, 46080, v252
    v_mfma_f32_16x16x32_bf16 v[96:99], v[160:163], v[184:187], v[96:99]
    s_lshr_b32 s70, s23, 1
    s_lshl_b32 s70, s70, 2
    v_mfma_f32_16x16x32_bf16 v[100:103], v[160:163], v[188:191], v[100:103]
    s_and_b32 s26, s24, 3
    s_add_u32 s70, s70, s26
    s_setprio 0
    v_mfma_f32_16x16x32_bf16 v[108:111], v[164:167], v[188:191], v[108:111]
    s_and_b32 s71, s23, 1
    s_lshl_b32 s71, s71, 3
    v_mfma_f32_16x16x32_bf16 v[104:107], v[164:167], v[184:187], v[104:107]
    s_lshr_b32 s27, s24, 2
    s_add_u32 s71, s71, s27
    v_mfma_f32_16x16x32_bf16 v[76:79], v[180:183], v[164:167], v[76:79]
    s_lshl_b32 s71, s71, 7
    s_lshl_b32 s101, s70, 8
    v_mfma_f32_16x16x32_bf16 v[72:75], v[176:179], v[164:167], v[72:75]
    s_and_b32 s33, s33, s35
    s_add_u32 s101, s101, 19927040
    s_lshl_b32 s39, s20, 14
    v_mfma_f32_16x16x32_bf16 v[44:47], v[172:175], v[164:167], v[44:47]
    s_add_u32 s39, s39, 16384
    v_mfma_f32_16x16x32_bf16 v[40:43], v[168:171], v[164:167], v[40:43]
    s_waitcnt vmcnt(5) lgkmcnt(0)
    s_barrier
    s_setprio 3
    v_mfma_f32_16x16x32_bf16 v[16:19], v[128:131], v[112:115], v[16:19]
    ds_read_b128 v[152:155], v204 offset:16384
    s_add_u32 m0, m0, 4096
    s_min_u32 s39, s39, 126976
    s_mov_b32 s32, 0x100000
    v_mfma_f32_16x16x32_bf16 v[20:23], v[132:135], v[112:115], v[20:23]
    ds_read_b64_tr_b16 v[168:169], v205 offset:12288
    s_lshl_b32 s40, s22, 13
    s_mov_b32 s74, 0
    v_mfma_f32_16x16x32_bf16 v[48:51], v[136:139], v[112:115], v[48:51]
    ds_read_b64_tr_b16 v[170:171], v205 offset:12800
    s_mov_b32 s51, 7
    s_and_b32 s28, s20, 3
    v_mfma_f32_16x16x32_bf16 v[52:55], v[140:143], v[112:115], v[52:55]
    ds_read_b64_tr_b16 v[172:173], v206 offset:12288
    buffer_load_dwordx4 v196, s[8:11], s29 offen offset:0  lds
    s_lshl_b32 s26, s26, 2
    s_add_u32 s26, s26, s28
    v_mfma_f32_16x16x32_bf16 v[80:83], v[112:115], v[144:147], v[80:83]
    ds_read_b64_tr_b16 v[174:175], v206 offset:12800
    s_lshl_b32 s26, s26, 17
    s_add_u32 s26, s26, s71
    v_mfma_f32_16x16x32_bf16 v[84:87], v[112:115], v[148:151], v[84:87]
    ds_read_b128 v[156:159], v204 offset:18432
    s_lshl_b32 s50, s70, 3
    s_add_u32 s27, s27, s50
    s_setprio 2
    v_mfma_f32_16x16x32_bf16 v[92:95], v[116:119], v[148:151], v[92:95]
    ds_read_b64_tr_b16 v[176:177], v205 offset:28672
    s_lshl_b32 s27, s27, 10
    v_lshlrev_b32 v14, 5, v0
    v_mfma_f32_16x16x32_bf16 v[88:91], v[116:119], v[144:147], v[88:91]
    ds_read_b64_tr_b16 v[178:179], v205 offset:29184
    buffer_load_dwordx4 v197, s[8:11], s29 offen offset:1024  lds
    s_lshl_b32 s46, s28, 20
    v_mfma_f32_16x16x32_bf16 v[60:63], v[140:143], v[116:119], v[60:63]
    ds_read_b64_tr_b16 v[180:181], v206 offset:28672
    s_add_u32 s46, s46, s27
    s_add_u32 s46, s46, 0
    v_mfma_f32_16x16x32_bf16 v[56:59], v[136:139], v[116:119], v[56:59]
    ds_read_b64_tr_b16 v[182:183], v206 offset:29184
    v_lshlrev_b32 v8, 17, v8
    v_lshl_add_u32 v8, v10, 7, v8
    v_mfma_f32_16x16x32_bf16 v[28:31], v[132:135], v[116:119], v[28:31]
    ds_read_b128 v[160:163], v204 offset:20480
    v_lshlrev_b32 v15, 11, v0
    s_cmp_eq_u32 s43, 0
    s_cselect_b32 s46, s26, s46
    s_cselect_b64 vcc, -1, 0
    s_lshl_b32 s28, s28, 1
    v_cndmask_b32 v15, v8, v15, vcc
    v_mfma_f32_16x16x32_bf16 v[24:27], v[128:131], v[116:119], v[24:27]
    ds_read_b64_tr_b16 v[184:185], v205 offset:45056
    buffer_load_dwordx4 v198, s[8:11], s29 offen offset:2048  lds
    s_add_u32 s28, s28, s50
    s_lshl_b32 s50, s43, 11
    s_setprio 1
    v_mfma_f32_16x16x32_bf16 v[32:35], v[128:131], v[120:123], v[32:35]
    ds_read_b64_tr_b16 v[186:187], v205 offset:45568
    s_add_u32 s50, s50, s28
    s_lshl_b32 s50, s50, 10
    v_mfma_f32_16x16x32_bf16 v[36:39], v[132:135], v[120:123], v[36:39]
    ds_read_b64_tr_b16 v[188:189], v206 offset:45056
    s_add_u32 s50, s50, 0
    s_lshl_b32 s53, s28, 6
    v_mfma_f32_16x16x32_bf16 v[64:67], v[136:139], v[120:123], v[64:67]
    ds_read_b64_tr_b16 v[190:191], v206 offset:45568
    s_add_u32 s53, s53, 17825792
    s_add_u32 s52, s28, s43
    v_mfma_f32_16x16x32_bf16 v[68:71], v[140:143], v[120:123], v[68:71]
    ds_read_b128 v[164:167], v204 offset:22528
    buffer_load_dwordx4 v199, s[8:11], s29 offen offset:3072  lds
    s_lshl_b32 s52, s52, 15
    v_mfma_f32_16x16x32_bf16 v[96:99], v[120:123], v[144:147], v[96:99]
    s_add_u32 s52, s52, s71
    v_lshlrev_b32 v250, 4, v236
    v_mfma_f32_16x16x32_bf16 v[100:103], v[120:123], v[148:151], v[100:103]
    v_bfe_u32 v8, v0, 4, 1
    v_lshrrev_b32 v9, 5, v0
    s_setprio 0
    v_mfma_f32_16x16x32_bf16 v[108:111], v[124:127], v[148:151], v[108:111]
    v_lshl_add_u32 v250, v8, 10, v250
    v_lshl_add_u32 v250, v9, 8, v250
    v_mfma_f32_16x16x32_bf16 v[104:107], v[124:127], v[144:147], v[104:107]
    buffer_load_dword v201, v200, s[8:11], s38 offen
    v_lshlrev_b32 v251, 11, v236
    v_lshl_add_u32 v251, v8, 5, v251
    v_mfma_f32_16x16x32_bf16 v[76:79], v[140:143], v[124:127], v[76:79]
    s_add_u32 s38, s38, s31
    v_lshl_add_u32 v251, v9, 4, v251
    v_bfe_u32 v10, v0, 3, 2
    v_mfma_f32_16x16x32_bf16 v[72:75], v[136:139], v[124:127], v[72:75]
    s_add_u32 s29, s29, s31
    v_and_b32 v11, 3, v0
    v_lshlrev_b32 v11, 3, v11
    v_mfma_f32_16x16x32_bf16 v[44:47], v[132:135], v[124:127], v[44:47]
    v_lshl_add_u32 v11, v10, 5, v11
    v_mfma_f32_16x16x32_bf16 v[40:43], v[128:131], v[124:127], v[40:43]
    s_waitcnt vmcnt(5) lgkmcnt(0)
    s_barrier
    s_setprio 3
    v_mfma_f32_16x16x32_bf16 v[16:19], v[168:171], v[152:155], v[16:19]
    ds_read_b128 v[112:115], v203 offset:32768
    s_add_u32 m0, s33, s36
    v_bfe_u32 v10, v0, 2, 2
    v_lshl_add_u32 v11, v10, 7, v11
    v_mfma_f32_16x16x32_bf16 v[20:23], v[172:175], v[152:155], v[20:23]
    ds_read_b64_tr_b16 v[128:129], v205 offset:0
    s_add_u32 s33, s33, s34
    s_lshl_b32 s26, s43, 16
    v_lshl_add_u32 v228, v237, 9, v11
    v_mfma_f32_16x16x32_bf16 v[48:51], v[176:179], v[152:155], v[48:51]
    ds_read_b64_tr_b16 v[130:131], v205 offset:512
    v_add_u32 v228, s26, v228
    v_lshl_add_u32 v11, v8, 9, v11
    v_mfma_f32_16x16x32_bf16 v[52:55], v[180:183], v[152:155], v[52:55]
    ds_read_b64_tr_b16 v[132:133], v206 offset:0
    buffer_load_dwordx4 v192, s[8:11], s29 offen offset:0  lds
    v_lshl_add_u32 v11, v9, 11, v11
    s_lshl_b32 s26, s43, 14
    v_mfma_f32_16x16x32_bf16 v[80:83], v[152:155], v[184:187], v[80:83]
    ds_read_b64_tr_b16 v[134:135], v206 offset:512
    s_add_u32 s26, s26, 131072
    v_add_u32 v232, s26, v11
    v_mfma_f32_16x16x32_bf16 v[84:87], v[152:155], v[188:191], v[84:87]
    ds_read_b128 v[116:119], v203 offset:34816
    v_xor_b32 v229, 32, v228
    v_xor_b32 v230, 64, v228
    s_setprio 2
    v_mfma_f32_16x16x32_bf16 v[92:95], v[156:159], v[188:191], v[92:95]
    ds_read_b64_tr_b16 v[136:137], v205 offset:16384
    v_xor_b32 v231, 96, v228
    v_xor_b32 v233, 32, v232
    v_mfma_f32_16x16x32_bf16 v[88:91], v[156:159], v[184:187], v[88:91]
    ds_read_b64_tr_b16 v[138:139], v205 offset:16896
    buffer_load_dwordx4 v193, s[8:11], s29 offen offset:1024  lds
    v_xor_b32 v234, 64, v232
    v_mfma_f32_16x16x32_bf16 v[60:63], v[180:183], v[156:159], v[60:63]
    ds_read_b64_tr_b16 v[140:141], v206 offset:16384
    v_xor_b32 v235, 96, v232
    s_mul_i32 s26, s20, 4352
    v_mfma_f32_16x16x32_bf16 v[56:59], v[176:179], v[156:159], v[56:59]
    ds_read_b64_tr_b16 v[142:143], v206 offset:16896
    s_add_u32 s26, s26, 126976
    s_xor_b32 s27, s20, 4
    v_mfma_f32_16x16x32_bf16 v[28:31], v[172:175], v[156:159], v[28:31]
    ds_read_b128 v[120:123], v203 offset:36864
    s_mul_i32 s27, s27, 4352
    s_add_u32 s27, s27, 126976
    v_mfma_f32_16x16x32_bf16 v[24:27], v[168:171], v[156:159], v[24:27]
    ds_read_b64_tr_b16 v[144:145], v205 offset:32768
    buffer_load_dwordx4 v194, s[8:11], s29 offen offset:2048  lds
    v_lshlrev_b32 v8, 2, v236
    v_add_u32 v4, s26, v12
    s_setprio 1
    v_mfma_f32_16x16x32_bf16 v[32:35], v[168:171], v[160:163], v[32:35]
    ds_read_b64_tr_b16 v[146:147], v205 offset:33280
    v_add_u32 v5, s27, v12
    v_lshlrev_b32 v6, 2, v0
    v_mfma_f32_16x16x32_bf16 v[36:39], v[172:175], v[160:163], v[36:39]
    ds_read_b64_tr_b16 v[148:149], v206 offset:32768
    v_add_u32 v7, s27, v6
    v_add_u32 v6, s26, v6
    v_mfma_f32_16x16x32_bf16 v[64:67], v[176:179], v[160:163], v[64:67]
    ds_read_b64_tr_b16 v[150:151], v206 offset:33280
    v_mov_b32 v10, 161792
    v_mov_b32 v11, 20480
    v_mfma_f32_16x16x32_bf16 v[68:71], v[180:183], v[160:163], v[68:71]
    ds_read_b128 v[124:127], v203 offset:38912
    buffer_load_dwordx4 v195, s[8:11], s29 offen offset:3072  lds
    s_lshl_b32 s26, s42, 1
    v_mfma_f32_16x16x32_bf16 v[96:99], v[160:163], v[184:187], v[96:99]
    s_add_u32 s26, s26, s41
    s_lshl_b32 s26, s26, 12
    v_mfma_f32_16x16x32_bf16 v[100:103], v[160:163], v[188:191], v[100:103]
    s_lshl_b32 s27, s43, 11
    s_add_u32 s27, s27, s26
    s_setprio 0
    v_mfma_f32_16x16x32_bf16 v[108:111], v[164:167], v[188:191], v[108:111]
    v_add_u32 v240, s26, v238
    v_add_u32 v241, s27, v12
    v_mfma_f32_16x16x32_bf16 v[104:107], v[164:167], v[184:187], v[104:107]
    v_xor_b32 v242, 2048, v241
    s_lshl_b32 s26, s42, 11
    v_mfma_f32_16x16x32_bf16 v[76:79], v[180:183], v[164:167], v[76:79]
    s_add_u32 s26, s26, 16384
    v_add_u32 v243, s26, v12
    v_mfma_f32_16x16x32_bf16 v[72:75], v[176:179], v[164:167], v[72:75]
    s_and_b32 s33, s33, s35
    s_lshl_b32 s26, s25, 12
    v_mov_b32 v226, 0x3e8293ee
    v_mfma_f32_16x16x32_bf16 v[44:47], v[172:175], v[164:167], v[44:47]
    v_mov_b32 v227, 0x3e8293ee
    v_mfma_f32_16x16x32_bf16 v[40:43], v[168:171], v[164:167], v[40:43]
    s_waitcnt vmcnt(5) lgkmcnt(0)
    s_barrier
    s_or_b32 s37, s2, s20
    s_cmp_lg_u32 s37, 0
    s_cbranch_scc1 Lnon6
    v_readfirstlane_b32 s37, v13
    s_mul_i32 s37, s37, 0x9e3779b1
    s_add_u32 s37, s37, 0x7f4a7c15
    s_lshr_b32 s3, s37, 15
    s_xor_b32 s37, s37, s3
    s_mul_i32 s37, s37, 0x85ebca6b
    s_or_b32 s37, s37, 4
    s_andn2_b32 s37, s37, 3
    v_mov_b32 v13, s37
    s_mov_b64 exec, 1
    buffer_store_dword v13, off, s[16:19], 0 sc1
    s_mov_b64 exec, -1
Lnon6:
    s_cmp_lt_u32 s20, 2
    s_cselect_b32 s3, 1, 99
    s_mov_b32 s37, 3
.p2align 6
Lp1:
    s_setprio 3
    v_mfma_f32_16x16x32_bf16 v[16:19], v[128:131], v[112:115], v[16:19]
    ds_read_b128 v[152:155], v204 offset:32768
    s_add_u32 m0, m0, 4096
    v_mfma_f32_16x16x32_bf16 v[20:23], v[132:135], v[112:115], v[20:23]
    ds_read_b64_tr_b16 v[168:169], v205 offset:4096
    v_mfma_f32_16x16x32_bf16 v[48:51], v[136:139], v[112:115], v[48:51]
    ds_read_b64_tr_b16 v[170:171], v205 offset:4608
    v_mfma_f32_16x16x32_bf16 v[52:55], v[140:143], v[112:115], v[52:55]
    ds_read_b64_tr_b16 v[172:173], v206 offset:4096
    buffer_load_dwordx4 v196, s[8:11], s29 offen offset:0  lds
    v_mfma_f32_16x16x32_bf16 v[80:83], v[112:115], v[144:147], v[80:83]
    ds_read_b64_tr_b16 v[174:175], v206 offset:4608
    v_mfma_f32_16x16x32_bf16 v[84:87], v[112:115], v[148:151], v[84:87]
    ds_read_b128 v[156:159], v204 offset:34816
    s_setprio 2
    v_mfma_f32_16x16x32_bf16 v[92:95], v[116:119], v[148:151], v[92:95]
    ds_read_b64_tr_b16 v[176:177], v205 offset:20480
    v_mfma_f32_16x16x32_bf16 v[88:91], v[116:119], v[144:147], v[88:91]
    ds_read_b64_tr_b16 v[178:179], v205 offset:20992
    buffer_load_dwordx4 v197, s[8:11], s29 offen offset:1024  lds
    v_mfma_f32_16x16x32_bf16 v[60:63], v[140:143], v[116:119], v[60:63]
    ds_read_b64_tr_b16 v[180:181], v206 offset:20480
    v_mfma_f32_16x16x32_bf16 v[56:59], v[136:139], v[116:119], v[56:59]
    ds_read_b64_tr_b16 v[182:183], v206 offset:20992
    v_mfma_f32_16x16x32_bf16 v[28:31], v[132:135], v[116:119], v[28:31]
    ds_read_b128 v[160:163], v204 offset:36864
    v_mfma_f32_16x16x32_bf16 v[24:27], v[128:131], v[116:119], v[24:27]
    ds_read_b64_tr_b16 v[184:185], v205 offset:36864
    buffer_load_dwordx4 v198, s[8:11], s29 offen offset:2048  lds
    s_setprio 1
    v_mfma_f32_16x16x32_bf16 v[32:35], v[128:131], v[120:123], v[32:35]
    ds_read_b64_tr_b16 v[186:187], v205 offset:37376
    v_mfma_f32_16x16x32_bf16 v[36:39], v[132:135], v[120:123], v[36:39]
    ds_read_b64_tr_b16 v[188:189], v206 offset:36864
    v_mfma_f32_16x16x32_bf16 v[64:67], v[136:139], v[120:123], v[64:67]
    ds_read_b64_tr_b16 v[190:191], v206 offset:37376
    v_mfma_f32_16x16x32_bf16 v[68:71], v[140:143], v[120:123], v[68:71]
    ds_read_b128 v[164:167], v204 offset:38912
    buffer_load_dwordx4 v199, s[8:11], s29 offen offset:3072  lds
    v_mfma_f32_16x16x32_bf16 v[96:99], v[120:123], v[144:147], v[96:99]
    v_mfma_f32_16x16x32_bf16 v[100:103], v[120:123], v[148:151], v[100:103]
    s_setprio 0
    v_mfma_f32_16x16x32_bf16 v[108:111], v[124:127], v[148:151], v[108:111]
    v_mfma_f32_16x16x32_bf16 v[104:107], v[124:127], v[144:147], v[104:107]
    buffer_load_dword v201, v200, s[8:11], s38 offen
    v_mfma_f32_16x16x32_bf16 v[76:79], v[140:143], v[124:127], v[76:79]
    s_add_u32 s38, s38, s31
    v_mfma_f32_16x16x32_bf16 v[72:75], v[136:139], v[124:127], v[72:75]
    s_add_u32 s29, s29, s31
    v_mfma_f32_16x16x32_bf16 v[44:47], v[132:135], v[124:127], v[44:47]
    v_mfma_f32_16x16x32_bf16 v[40:43], v[128:131], v[124:127], v[40:43]
    s_waitcnt vmcnt(5) lgkmcnt(0)
    s_barrier
    s_setprio 3
    v_mfma_f32_16x16x32_bf16 v[16:19], v[168:171], v[152:155], v[16:19]
    ds_read_b128 v[112:115], v203 offset:49152
    s_add_u32 m0, s33, s36
    v_mfma_f32_16x16x32_bf16 v[20:23], v[172:175], v[152:155], v[20:23]
    ds_read_b64_tr_b16 v[128:129], v205 offset:8192
    s_add_u32 s33, s33, s34
    v_mfma_f32_16x16x32_bf16 v[48:51], v[176:179], v[152:155], v[48:51]
    ds_read_b64_tr_b16 v[130:131], v205 offset:8704
    v_mfma_f32_16x16x32_bf16 v[52:55], v[180:183], v[152:155], v[52:55]
    ds_read_b64_tr_b16 v[132:133], v206 offset:8192
    buffer_load_dwordx4 v192, s[8:11], s29 offen offset:0  lds
    v_mfma_f32_16x16x32_bf16 v[80:83], v[152:155], v[184:187], v[80:83]
    ds_read_b64_tr_b16 v[134:135], v206 offset:8704
    v_mfma_f32_16x16x32_bf16 v[84:87], v[152:155], v[188:191], v[84:87]
    ds_read_b128 v[116:119], v203 offset:51200
    s_setprio 2
    v_mfma_f32_16x16x32_bf16 v[92:95], v[156:159], v[188:191], v[92:95]
    ds_read_b64_tr_b16 v[136:137], v205 offset:24576
    v_mfma_f32_16x16x32_bf16 v[88:91], v[156:159], v[184:187], v[88:91]
    ds_read_b64_tr_b16 v[138:139], v205 offset:25088
    buffer_load_dwordx4 v193, s[8:11], s29 offen offset:1024  lds
    v_mfma_f32_16x16x32_bf16 v[60:63], v[180:183], v[156:159], v[60:63]
    ds_read_b64_tr_b16 v[140:141], v206 offset:24576
    v_mfma_f32_16x16x32_bf16 v[56:59], v[176:179], v[156:159], v[56:59]
    ds_read_b64_tr_b16 v[142:143], v206 offset:25088
    v_mfma_f32_16x16x32_bf16 v[28:31], v[172:175], v[156:159], v[28:31]
    ds_read_b128 v[120:123], v203 offset:53248
    v_mfma_f32_16x16x32_bf16 v[24:27], v[168:171], v[156:159], v[24:27]
    ds_read_b64_tr_b16 v[144:145], v205 offset:40960
    buffer_load_dwordx4 v194, s[8:11], s29 offen offset:2048  lds
    s_setprio 1
    v_mfma_f32_16x16x32_bf16 v[32:35], v[168:171], v[160:163], v[32:35]
    ds_read_b64_tr_b16 v[146:147], v205 offset:41472
    v_mfma_f32_16x16x32_bf16 v[36:39], v[172:175], v[160:163], v[36:39]
    ds_read_b64_tr_b16 v[148:149], v206 offset:40960
    v_mfma_f32_16x16x32_bf16 v[64:67], v[176:179], v[160:163], v[64:67]
    ds_read_b64_tr_b16 v[150:151], v206 offset:41472
    v_mfma_f32_16x16x32_bf16 v[68:71], v[180:183], v[160:163], v[68:71]
    ds_read_b128 v[124:127], v203 offset:55296
    buffer_load_dwordx4 v195, s[8:11], s29 offen offset:3072  lds
    v_mfma_f32_16x16x32_bf16 v[96:99], v[160:163], v[184:187], v[96:99]
    v_mfma_f32_16x16x32_bf16 v[100:103], v[160:163], v[188:191], v[100:103]
    s_setprio 0
    v_mfma_f32_16x16x32_bf16 v[108:111], v[164:167], v[188:191], v[108:111]
    v_mfma_f32_16x16x32_bf16 v[104:107], v[164:167], v[184:187], v[104:107]
    v_mfma_f32_16x16x32_bf16 v[76:79], v[180:183], v[164:167], v[76:79]
    v_mfma_f32_16x16x32_bf16 v[72:75], v[176:179], v[164:167], v[72:75]
    s_and_b32 s33, s33, s35
    v_mfma_f32_16x16x32_bf16 v[44:47], v[172:175], v[164:167], v[44:47]
    v_mfma_f32_16x16x32_bf16 v[40:43], v[168:171], v[164:167], v[40:43]
    s_waitcnt vmcnt(5) lgkmcnt(0)
    s_barrier
    s_setprio 3
    v_mfma_f32_16x16x32_bf16 v[16:19], v[128:131], v[112:115], v[16:19]
    ds_read_b128 v[152:155], v204 offset:49152
    s_add_u32 m0, m0, 4096
    v_mfma_f32_16x16x32_bf16 v[20:23], v[132:135], v[112:115], v[20:23]
    ds_read_b64_tr_b16 v[168:169], v205 offset:12288
    v_mfma_f32_16x16x32_bf16 v[48:51], v[136:139], v[112:115], v[48:51]
    ds_read_b64_tr_b16 v[170:171], v205 offset:12800
    v_mfma_f32_16x16x32_bf16 v[52:55], v[140:143], v[112:115], v[52:55]
    ds_read_b64_tr_b16 v[172:173], v206 offset:12288
    buffer_load_dwordx4 v196, s[8:11], s29 offen offset:0  lds
    v_mfma_f32_16x16x32_bf16 v[80:83], v[112:115], v[144:147], v[80:83]
    ds_read_b64_tr_b16 v[174:175], v206 offset:12800
    v_mfma_f32_16x16x32_bf16 v[84:87], v[112:115], v[148:151], v[84:87]
    ds_read_b128 v[156:159], v204 offset:51200
    s_setprio 2
    v_mfma_f32_16x16x32_bf16 v[92:95], v[116:119], v[148:151], v[92:95]
    ds_read_b64_tr_b16 v[176:177], v205 offset:28672
    v_mfma_f32_16x16x32_bf16 v[88:91], v[116:119], v[144:147], v[88:91]
    ds_read_b64_tr_b16 v[178:179], v205 offset:29184
    buffer_load_dwordx4 v197, s[8:11], s29 offen offset:1024  lds
    v_mfma_f32_16x16x32_bf16 v[60:63], v[140:143], v[116:119], v[60:63]
    ds_read_b64_tr_b16 v[180:181], v206 offset:28672
    v_mfma_f32_16x16x32_bf16 v[56:59], v[136:139], v[116:119], v[56:59]
    ds_read_b64_tr_b16 v[182:183], v206 offset:29184
    v_mfma_f32_16x16x32_bf16 v[28:31], v[132:135], v[116:119], v[28:31]
    ds_read_b128 v[160:163], v204 offset:53248
    v_mfma_f32_16x16x32_bf16 v[24:27], v[128:131], v[116:119], v[24:27]
    ds_read_b64_tr_b16 v[184:185], v205 offset:45056
    buffer_load_dwordx4 v198, s[8:11], s29 offen offset:2048  lds
    s_setprio 1
    v_mfma_f32_16x16x32_bf16 v[32:35], v[128:131], v[120:123], v[32:35]
    ds_read_b64_tr_b16 v[186:187], v205 offset:45568
    v_mfma_f32_16x16x32_bf16 v[36:39], v[132:135], v[120:123], v[36:39]
    ds_read_b64_tr_b16 v[188:189], v206 offset:45056
    v_mfma_f32_16x16x32_bf16 v[64:67], v[136:139], v[120:123], v[64:67]
    ds_read_b64_tr_b16 v[190:191], v206 offset:45568
    v_mfma_f32_16x16x32_bf16 v[68:71], v[140:143], v[120:123], v[68:71]
    ds_read_b128 v[164:167], v204 offset:55296
    buffer_load_dwordx4 v199, s[8:11], s29 offen offset:3072  lds
    v_mfma_f32_16x16x32_bf16 v[96:99], v[120:123], v[144:147], v[96:99]
    v_mfma_f32_16x16x32_bf16 v[100:103], v[120:123], v[148:151], v[100:103]
    s_setprio 0
    v_mfma_f32_16x16x32_bf16 v[108:111], v[124:127], v[148:151], v[108:111]
    v_mfma_f32_16x16x32_bf16 v[104:107], v[124:127], v[144:147], v[104:107]
    buffer_load_dword v201, v200, s[8:11], s38 offen
    v_mfma_f32_16x16x32_bf16 v[76:79], v[140:143], v[124:127], v[76:79]
    s_add_u32 s38, s38, s31
    v_mfma_f32_16x16x32_bf16 v[72:75], v[136:139], v[124:127], v[72:75]
    s_add_u32 s29, s29, s31
    v_mfma_f32_16x16x32_bf16 v[44:47], v[132:135], v[124:127], v[44:47]
    v_mfma_f32_16x16x32_bf16 v[40:43], v[128:131], v[124:127], v[40:43]
    s_waitcnt vmcnt(5) lgkmcnt(0)
    s_barrier
    s_setprio 3
    v_mfma_f32_16x16x32_bf16 v[16:19], v[168:171], v[152:155], v[16:19]
    ds_read_b128 v[112:115], v203 offset:0
    s_add_u32 m0, s33, s36
    v_mfma_f32_16x16x32_bf16 v[20:23], v[172:175], v[152:155], v[20:23]
    ds_read_b64_tr_b16 v[128:129], v205 offset:0
    s_add_u32 s33, s33, s34
    v_mfma_f32_16x16x32_bf16 v[48:51], v[176:179], v[152:155], v[48:51]
    ds_read_b64_tr_b16 v[130:131], v205 offset:512
    v_mfma_f32_16x16x32_bf16 v[52:55], v[180:183], v[152:155], v[52:55]
    ds_read_b64_tr_b16 v[132:133], v206 offset:0
    buffer_load_dwordx4 v192, s[8:11], s29 offen offset:0  lds
    v_mfma_f32_16x16x32_bf16 v[80:83], v[152:155], v[184:187], v[80:83]
    ds_read_b64_tr_b16 v[134:135], v206 offset:512
    v_mfma_f32_16x16x32_bf16 v[84:87], v[152:155], v[188:191], v[84:87]
    ds_read_b128 v[116:119], v203 offset:2048
    s_setprio 2
    v_mfma_f32_16x16x32_bf16 v[92:95], v[156:159], v[188:191], v[92:95]
    ds_read_b64_tr_b16 v[136:137], v205 offset:16384
    v_mfma_f32_16x16x32_bf16 v[88:91], v[156:159], v[184:187], v[88:91]
    ds_read_b64_tr_b16 v[138:139], v205 offset:16896
    buffer_load_dwordx4 v193, s[8:11], s29 offen offset:1024  lds
    v_mfma_f32_16x16x32_bf16 v[60:63], v[180:183], v[156:159], v[60:63]
    ds_read_b64_tr_b16 v[140:141], v206 offset:16384
    v_mfma_f32_16x16x32_bf16 v[56:59], v[176:179], v[156:159], v[56:59]
    ds_read_b64_tr_b16 v[142:143], v206 offset:16896
    v_mfma_f32_16x16x32_bf16 v[28:31], v[172:175], v[156:159], v[28:31]
    ds_read_b128 v[120:123], v203 offset:4096
    v_mfma_f32_16x16x32_bf16 v[24:27], v[168:171], v[156:159], v[24:27]
    ds_read_b64_tr_b16 v[144:145], v205 offset:32768
    buffer_load_dwordx4 v194, s[8:11], s29 offen offset:2048  lds
    s_setprio 1
    v_mfma_f32_16x16x32_bf16 v[32:35], v[168:171], v[160:163], v[32:35]
    ds_read_b64_tr_b16 v[146:147], v205 offset:33280
    v_mfma_f32_16x16x32_bf16 v[36:39], v[172:175], v[160:163], v[36:39]
    ds_read_b64_tr_b16 v[148:149], v206 offset:32768
    v_mfma_f32_16x16x32_bf16 v[64:67], v[176:179], v[160:163], v[64:67]
    ds_read_b64_tr_b16 v[150:151], v206 offset:33280
    v_mfma_f32_16x16x32_bf16 v[68:71], v[180:183], v[160:163], v[68:71]
    ds_read_b128 v[124:127], v203 offset:6144
    buffer_load_dwordx4 v195, s[8:11], s29 offen offset:3072  lds
    v_mfma_f32_16x16x32_bf16 v[96:99], v[160:163], v[184:187], v[96:99]
    v_mfma_f32_16x16x32_bf16 v[100:103], v[160:163], v[188:191], v[100:103]
    s_setprio 0
    v_mfma_f32_16x16x32_bf16 v[108:111], v[164:167], v[188:191], v[108:111]
    v_mfma_f32_16x16x32_bf16 v[104:107], v[164:167], v[184:187], v[104:107]
    v_mfma_f32_16x16x32_bf16 v[76:79], v[180:183], v[164:167], v[76:79]
    v_mfma_f32_16x16x32_bf16 v[72:75], v[176:179], v[164:167], v[72:75]
    s_and_b32 s33, s33, s35
    v_mfma_f32_16x16x32_bf16 v[44:47], v[172:175], v[164:167], v[44:47]
    v_mfma_f32_16x16x32_bf16 v[40:43], v[168:171], v[164:167], v[40:43]
    s_waitcnt vmcnt(5) lgkmcnt(0)
    s_barrier
    s_setprio 3
    v_mfma_f32_16x16x32_bf16 v[16:19], v[128:131], v[112:115], v[16:19]
    ds_read_b128 v[152:155], v204 offset:0
    s_add_u32 m0, m0, 4096
    v_mfma_f32_16x16x32_bf16 v[20:23], v[132:135], v[112:115], v[20:23]
    ds_read_b64_tr_b16 v[168:169], v205 offset:4096
    v_mfma_f32_16x16x32_bf16 v[48:51], v[136:139], v[112:115], v[48:51]
    ds_read_b64_tr_b16 v[170:171], v205 offset:4608
    v_mfma_f32_16x16x32_bf16 v[52:55], v[140:143], v[112:115], v[52:55]
    ds_read_b64_tr_b16 v[172:173], v206 offset:4096
    buffer_load_dwordx4 v196, s[8:11], s29 offen offset:0  lds
    v_mfma_f32_16x16x32_bf16 v[80:83], v[112:115], v[144:147], v[80:83]
    ds_read_b64_tr_b16 v[174:175], v206 offset:4608
    v_mfma_f32_16x16x32_bf16 v[84:87], v[112:115], v[148:151], v[84:87]
    ds_read_b128 v[156:159], v204 offset:2048
    s_setprio 2
    v_mfma_f32_16x16x32_bf16 v[92:95], v[116:119], v[148:151], v[92:95]
    ds_read_b64_tr_b16 v[176:177], v205 offset:20480
    v_mfma_f32_16x16x32_bf16 v[88:91], v[116:119], v[144:147], v[88:91]
    ds_read_b64_tr_b16 v[178:179], v205 offset:20992
    buffer_load_dwordx4 v197, s[8:11], s29 offen offset:1024  lds
    v_mfma_f32_16x16x32_bf16 v[60:63], v[140:143], v[116:119], v[60:63]
    ds_read_b64_tr_b16 v[180:181], v206 offset:20480
    v_mfma_f32_16x16x32_bf16 v[56:59], v[136:139], v[116:119], v[56:59]
    ds_read_b64_tr_b16 v[182:183], v206 offset:20992
    v_mfma_f32_16x16x32_bf16 v[28:31], v[132:135], v[116:119], v[28:31]
    ds_read_b128 v[160:163], v204 offset:4096
    v_mfma_f32_16x16x32_bf16 v[24:27], v[128:131], v[116:119], v[24:27]
    ds_read_b64_tr_b16 v[184:185], v205 offset:36864
    buffer_load_dwordx4 v198, s[8:11], s29 offen offset:2048  lds
    s_setprio 1
    v_mfma_f32_16x16x32_bf16 v[32:35], v[128:131], v[120:123], v[32:35]
    ds_read_b64_tr_b16 v[186:187], v205 offset:37376
    v_mfma_f32_16x16x32_bf16 v[36:39], v[132:135], v[120:123], v[36:39]
    ds_read_b64_tr_b16 v[188:189], v206 offset:36864
    v_mfma_f32_16x16x32_bf16 v[64:67], v[136:139], v[120:123], v[64:67]
    ds_read_b64_tr_b16 v[190:191], v206 offset:37376
    v_mfma_f32_16x16x32_bf16 v[68:71], v[140:143], v[120:123], v[68:71]
    ds_read_b128 v[164:167], v204 offset:6144
    buffer_load_dwordx4 v199, s[8:11], s29 offen offset:3072  lds
    v_mfma_f32_16x16x32_bf16 v[96:99], v[120:123], v[144:147], v[96:99]
    v_mfma_f32_16x16x32_bf16 v[100:103], v[120:123], v[148:151], v[100:103]
    s_setprio 0
    v_mfma_f32_16x16x32_bf16 v[108:111], v[124:127], v[148:151], v[108:111]
    v_mfma_f32_16x16x32_bf16 v[104:107], v[124:127], v[144:147], v[104:107]
    buffer_load_dword v201, v200, s[8:11], s38 offen
    v_mfma_f32_16x16x32_bf16 v[76:79], v[140:143], v[124:127], v[76:79]
    s_add_u32 s38, s38, s31
    v_mfma_f32_16x16x32_bf16 v[72:75], v[136:139], v[124:127], v[72:75]
    s_add_u32 s29, s29, s31
    v_mfma_f32_16x16x32_bf16 v[44:47], v[132:135], v[124:127], v[44:47]
    v_mfma_f32_16x16x32_bf16 v[40:43], v[128:131], v[124:127], v[40:43]
    s_waitcnt vmcnt(5) lgkmcnt(0)
    s_barrier
    s_setprio 3
    v_mfma_f32_16x16x32_bf16 v[16:19], v[168:171], v[152:155], v[16:19]
    ds_read_b128 v[112:115], v203 offset:16384
    s_add_u32 m0, s33, s36
    v_mfma_f32_16x16x32_bf16 v[20:23], v[172:175], v[152:155], v[20:23]
    ds_read_b64_tr_b16 v[128:129], v205 offset:8192
    s_add_u32 s33, s33, s34
    v_mfma_f32_16x16x32_bf16 v[48:51], v[176:179], v[152:155], v[48:51]
    ds_read_b64_tr_b16 v[130:131], v205 offset:8704
    v_mfma_f32_16x16x32_bf16 v[52:55], v[180:183], v[152:155], v[52:55]
    ds_read_b64_tr_b16 v[132:133], v206 offset:8192
    buffer_load_dwordx4 v192, s[8:11], s29 offen offset:0  lds
    v_mfma_f32_16x16x32_bf16 v[80:83], v[152:155], v[184:187], v[80:83]
    ds_read_b64_tr_b16 v[134:135], v206 offset:8704
    v_mfma_f32_16x16x32_bf16 v[84:87], v[152:155], v[188:191], v[84:87]
    ds_read_b128 v[116:119], v203 offset:18432
    s_setprio 2
    v_mfma_f32_16x16x32_bf16 v[92:95], v[156:159], v[188:191], v[92:95]
    ds_read_b64_tr_b16 v[136:137], v205 offset:24576
    v_mfma_f32_16x16x32_bf16 v[88:91], v[156:159], v[184:187], v[88:91]
    ds_read_b64_tr_b16 v[138:139], v205 offset:25088
    buffer_load_dwordx4 v193, s[8:11], s29 offen offset:1024  lds
    v_mfma_f32_16x16x32_bf16 v[60:63], v[180:183], v[156:159], v[60:63]
    ds_read_b64_tr_b16 v[140:141], v206 offset:24576
    v_mfma_f32_16x16x32_bf16 v[56:59], v[176:179], v[156:159], v[56:59]
    ds_read_b64_tr_b16 v[142:143], v206 offset:25088
    v_mfma_f32_16x16x32_bf16 v[28:31], v[172:175], v[156:159], v[28:31]
    ds_read_b128 v[120:123], v203 offset:20480
    v_mfma_f32_16x16x32_bf16 v[24:27], v[168:171], v[156:159], v[24:27]
    ds_read_b64_tr_b16 v[144:145], v205 offset:40960
    buffer_load_dwordx4 v194, s[8:11], s29 offen offset:2048  lds
    s_setprio 1
    v_mfma_f32_16x16x32_bf16 v[32:35], v[168:171], v[160:163], v[32:35]
    ds_read_b64_tr_b16 v[146:147], v205 offset:41472
    v_mfma_f32_16x16x32_bf16 v[36:39], v[172:175], v[160:163], v[36:39]
    ds_read_b64_tr_b16 v[148:149], v206 offset:40960
    v_mfma_f32_16x16x32_bf16 v[64:67], v[176:179], v[160:163], v[64:67]
    ds_read_b64_tr_b16 v[150:151], v206 offset:41472
    v_mfma_f32_16x16x32_bf16 v[68:71], v[180:183], v[160:163], v[68:71]
    ds_read_b128 v[124:127], v203 offset:22528
    buffer_load_dwordx4 v195, s[8:11], s29 offen offset:3072  lds
    v_mfma_f32_16x16x32_bf16 v[96:99], v[160:163], v[184:187], v[96:99]
    v_mfma_f32_16x16x32_bf16 v[100:103], v[160:163], v[188:191], v[100:103]
    s_setprio 0
    v_mfma_f32_16x16x32_bf16 v[108:111], v[164:167], v[188:191], v[108:111]
    v_mfma_f32_16x16x32_bf16 v[104:107], v[164:167], v[184:187], v[104:107]
    v_mfma_f32_16x16x32_bf16 v[76:79], v[180:183], v[164:167], v[76:79]
    v_mfma_f32_16x16x32_bf16 v[72:75], v[176:179], v[164:167], v[72:75]
    s_and_b32 s33, s33, s35
    v_mfma_f32_16x16x32_bf16 v[44:47], v[172:175], v[164:167], v[44:47]
    v_mfma_f32_16x16x32_bf16 v[40:43], v[168:171], v[164:167], v[40:43]
    s_waitcnt vmcnt(5) lgkmcnt(0)
    s_barrier
    s_setprio 3
    v_mfma_f32_16x16x32_bf16 v[16:19], v[128:131], v[112:115], v[16:19]
    ds_read_b128 v[152:155], v204 offset:16384
    s_add_u32 m0, m0, 4096
    v_mfma_f32_16x16x32_bf16 v[20:23], v[132:135], v[112:115], v[20:23]
    ds_read_b64_tr_b16 v[168:169], v205 offset:12288
    v_mfma_f32_16x16x32_bf16 v[48:51], v[136:139], v[112:115], v[48:51]
    ds_read_b64_tr_b16 v[170:171], v205 offset:12800
    v_mfma_f32_16x16x32_bf16 v[52:55], v[140:143], v[112:115], v[52:55]
    ds_read_b64_tr_b16 v[172:173], v206 offset:12288
    buffer_load_dwordx4 v196, s[8:11], s29 offen offset:0  lds
    v_mfma_f32_16x16x32_bf16 v[80:83], v[112:115], v[144:147], v[80:83]
    ds_read_b64_tr_b16 v[174:175], v206 offset:12800
    v_mfma_f32_16x16x32_bf16 v[84:87], v[112:115], v[148:151], v[84:87]
    ds_read_b128 v[156:159], v204 offset:18432
    s_setprio 2
    v_mfma_f32_16x16x32_bf16 v[92:95], v[116:119], v[148:151], v[92:95]
    ds_read_b64_tr_b16 v[176:177], v205 offset:28672
    v_mfma_f32_16x16x32_bf16 v[88:91], v[116:119], v[144:147], v[88:91]
    ds_read_b64_tr_b16 v[178:179], v205 offset:29184
    buffer_load_dwordx4 v197, s[8:11], s29 offen offset:1024  lds
    v_mfma_f32_16x16x32_bf16 v[60:63], v[140:143], v[116:119], v[60:63]
    ds_read_b64_tr_b16 v[180:181], v206 offset:28672
    v_mfma_f32_16x16x32_bf16 v[56:59], v[136:139], v[116:119], v[56:59]
    ds_read_b64_tr_b16 v[182:183], v206 offset:29184
    v_mfma_f32_16x16x32_bf16 v[28:31], v[132:135], v[116:119], v[28:31]
    ds_read_b128 v[160:163], v204 offset:20480
    v_mfma_f32_16x16x32_bf16 v[24:27], v[128:131], v[116:119], v[24:27]
    ds_read_b64_tr_b16 v[184:185], v205 offset:45056
    buffer_load_dwordx4 v198, s[8:11], s29 offen offset:2048  lds
    s_setprio 1
    v_mfma_f32_16x16x32_bf16 v[32:35], v[128:131], v[120:123], v[32:35]
    ds_read_b64_tr_b16 v[186:187], v205 offset:45568
    v_mfma_f32_16x16x32_bf16 v[36:39], v[132:135], v[120:123], v[36:39]
    ds_read_b64_tr_b16 v[188:189], v206 offset:45056
    v_mfma_f32_16x16x32_bf16 v[64:67], v[136:139], v[120:123], v[64:67]
    ds_read_b64_tr_b16 v[190:191], v206 offset:45568
    v_mfma_f32_16x16x32_bf16 v[68:71], v[140:143], v[120:123], v[68:71]
    ds_read_b128 v[164:167], v204 offset:22528
    buffer_load_dwordx4 v199, s[8:11], s29 offen offset:3072  lds
    v_mfma_f32_16x16x32_bf16 v[96:99], v[120:123], v[144:147], v[96:99]
    v_mfma_f32_16x16x32_bf16 v[100:103], v[120:123], v[148:151], v[100:103]
    s_setprio 0
    v_mfma_f32_16x16x32_bf16 v[108:111], v[124:127], v[148:151], v[108:111]
    v_mfma_f32_16x16x32_bf16 v[104:107], v[124:127], v[144:147], v[104:107]
    buffer_load_dword v201, v200, s[8:11], s38 offen
    v_mfma_f32_16x16x32_bf16 v[76:79], v[140:143], v[124:127], v[76:79]
    s_add_u32 s38, s38, s31
    v_mfma_f32_16x16x32_bf16 v[72:75], v[136:139], v[124:127], v[72:75]
    s_add_u32 s29, s29, s31
    v_mfma_f32_16x16x32_bf16 v[44:47], v[132:135], v[124:127], v[44:47]
    v_mfma_f32_16x16x32_bf16 v[40:43], v[128:131], v[124:127], v[40:43]
    s_waitcnt vmcnt(5) lgkmcnt(0)
    s_barrier
    s_cmp_eq_u32 s3, s37
    s_cselect_b32 s29, 0x40000000, s29
    s_cselect_b32 s36, 0x30000, s36
    s_cselect_b32 s33, 0, s33
    s_setprio 3
    v_mfma_f32_16x16x32_bf16 v[16:19], v[168:171], v[152:155], v[16:19]
    ds_read_b128 v[112:115], v203 offset:32768
    s_add_u32 m0, s33, s36
    v_mfma_f32_16x16x32_bf16 v[20:23], v[172:175], v[152:155], v[20:23]
    ds_read_b64_tr_b16 v[128:129], v205 offset:0
    s_add_u32 s33, s33, s34
    v_mfma_f32_16x16x32_bf16 v[48:51], v[176:179], v[152:155], v[48:51]
    ds_read_b64_tr_b16 v[130:131], v205 offset:512
    v_mfma_f32_16x16x32_bf16 v[52:55], v[180:183], v[152:155], v[52:55]
    ds_read_b64_tr_b16 v[132:133], v206 offset:0
    buffer_load_dwordx4 v192, s[8:11], s29 offen offset:0  lds
    v_mfma_f32_16x16x32_bf16 v[80:83], v[152:155], v[184:187], v[80:83]
    ds_read_b64_tr_b16 v[134:135], v206 offset:512
    v_mfma_f32_16x16x32_bf16 v[84:87], v[152:155], v[188:191], v[84:87]
    ds_read_b128 v[116:119], v203 offset:34816
    s_setprio 2
    v_mfma_f32_16x16x32_bf16 v[92:95], v[156:159], v[188:191], v[92:95]
    ds_read_b64_tr_b16 v[136:137], v205 offset:16384
    v_mfma_f32_16x16x32_bf16 v[88:91], v[156:159], v[184:187], v[88:91]
    ds_read_b64_tr_b16 v[138:139], v205 offset:16896
    buffer_load_dwordx4 v193, s[8:11], s29 offen offset:1024  lds
    v_mfma_f32_16x16x32_bf16 v[60:63], v[180:183], v[156:159], v[60:63]
    ds_read_b64_tr_b16 v[140:141], v206 offset:16384
    v_mfma_f32_16x16x32_bf16 v[56:59], v[176:179], v[156:159], v[56:59]
    ds_read_b64_tr_b16 v[142:143], v206 offset:16896
    v_mfma_f32_16x16x32_bf16 v[28:31], v[172:175], v[156:159], v[28:31]
    ds_read_b128 v[120:123], v203 offset:36864
    v_mfma_f32_16x16x32_bf16 v[24:27], v[168:171], v[156:159], v[24:27]
    ds_read_b64_tr_b16 v[144:145], v205 offset:32768
    buffer_load_dwordx4 v194, s[8:11], s29 offen offset:2048  lds
    s_setprio 1
    v_mfma_f32_16x16x32_bf16 v[32:35], v[168:171], v[160:163], v[32:35]
    ds_read_b64_tr_b16 v[146:147], v205 offset:33280
    v_mfma_f32_16x16x32_bf16 v[36:39], v[172:175], v[160:163], v[36:39]
    ds_read_b64_tr_b16 v[148:149], v206 offset:32768
    v_mfma_f32_16x16x32_bf16 v[64:67], v[176:179], v[160:163], v[64:67]
    ds_read_b64_tr_b16 v[150:151], v206 offset:33280
    v_mfma_f32_16x16x32_bf16 v[68:71], v[180:183], v[160:163], v[68:71]
    ds_read_b128 v[124:127], v203 offset:38912
    buffer_load_dwordx4 v195, s[8:11], s29 offen offset:3072  lds
    v_mfma_f32_16x16x32_bf16 v[96:99], v[160:163], v[184:187], v[96:99]
    v_mfma_f32_16x16x32_bf16 v[100:103], v[160:163], v[188:191], v[100:103]
    s_setprio 0
    v_mfma_f32_16x16x32_bf16 v[108:111], v[164:167], v[188:191], v[108:111]
    v_mfma_f32_16x16x32_bf16 v[104:107], v[164:167], v[184:187], v[104:107]
    v_mfma_f32_16x16x32_bf16 v[76:79], v[180:183], v[164:167], v[76:79]
    v_mfma_f32_16x16x32_bf16 v[72:75], v[176:179], v[164:167], v[72:75]
    s_and_b32 s33, s33, s35
    v_mfma_f32_16x16x32_bf16 v[44:47], v[172:175], v[164:167], v[44:47]
    v_mfma_f32_16x16x32_bf16 v[40:43], v[168:171], v[164:167], v[40:43]
    s_waitcnt vmcnt(5) lgkmcnt(0)
    s_barrier
    s_sub_u32 s37, s37, 1
    s_cmp_lg_u32 s37, 0
    s_cbranch_scc1 Lp1
    s_cmp_lg_u32 s20, 0
    s_cbranch_scc1 Lnon1
    buffer_load_dword v13, off, s[16:19], 0 sc1
Lnon1:
    s_add_u32 m0, m0, 4096
    s_nop 0
    buffer_load_dwordx4 v196, s[8:11], s29 offen offset:0  lds
    buffer_load_dwordx4 v197, s[8:11], s29 offen offset:1024  lds
    buffer_load_dwordx4 v198, s[8:11], s29 offen offset:2048  lds
    buffer_load_dwordx4 v199, s[8:11], s29 offen offset:3072  lds
    s_add_u32 s29, s29, s31
    buffer_load_dword v201, v202, s[64:67], s75 offen
    s_setprio 3
    v_mfma_f32_16x16x32_bf16 v[16:19], v[128:131], v[112:115], v[16:19]
    ds_read_b128 v[152:155], v204 offset:32768
    v_mfma_f32_16x16x32_bf16 v[20:23], v[132:135], v[112:115], v[20:23]
    ds_read_b64_tr_b16 v[168:169], v205 offset:4096
    v_mfma_f32_16x16x32_bf16 v[48:51], v[136:139], v[112:115], v[48:51]
    ds_read_b64_tr_b16 v[170:171], v205 offset:4608
    v_mfma_f32_16x16x32_bf16 v[52:55], v[140:143], v[112:115], v[52:55]
    ds_read_b64_tr_b16 v[172:173], v206 offset:4096
    v_mfma_f32_16x16x32_bf16 v[80:83], v[112:115], v[144:147], v[80:83]
    ds_read_b64_tr_b16 v[174:175], v206 offset:4608
    v_mfma_f32_16x16x32_bf16 v[84:87], v[112:115], v[148:151], v[84:87]
    ds_read_b128 v[156:159], v204 offset:34816
    s_setprio 2
    v_mfma_f32_16x16x32_bf16 v[92:95], v[116:119], v[148:151], v[92:95]
    ds_read_b64_tr_b16 v[176:177], v205 offset:20480
    v_mfma_f32_16x16x32_bf16 v[88:91], v[116:119], v[144:147], v[88:91]
    ds_read_b64_tr_b16 v[178:179], v205 offset:20992
    v_mfma_f32_16x16x32_bf16 v[60:63], v[140:143], v[116:119], v[60:63]
    ds_read_b64_tr_b16 v[180:181], v206 offset:20480
    v_mfma_f32_16x16x32_bf16 v[56:59], v[136:139], v[116:119], v[56:59]
    ds_read_b64_tr_b16 v[182:183], v206 offset:20992
    v_mfma_f32_16x16x32_bf16 v[28:31], v[132:135], v[116:119], v[28:31]
    ds_read_b128 v[160:163], v204 offset:36864
    v_mfma_f32_16x16x32_bf16 v[24:27], v[128:131], v[116:119], v[24:27]
    ds_read_b64_tr_b16 v[184:185], v205 offset:36864
    s_setprio 1
    v_mfma_f32_16x16x32_bf16 v[32:35], v[128:131], v[120:123], v[32:35]
    ds_read_b64_tr_b16 v[186:187], v205 offset:37376
    v_mfma_f32_16x16x32_bf16 v[36:39], v[132:135], v[120:123], v[36:39]
    ds_read_b64_tr_b16 v[188:189], v206 offset:36864
    v_mfma_f32_16x16x32_bf16 v[64:67], v[136:139], v[120:123], v[64:67]
    ds_read_b64_tr_b16 v[190:191], v206 offset:37376
    v_mfma_f32_16x16x32_bf16 v[68:71], v[140:143], v[120:123], v[68:71]
    ds_read_b128 v[164:167], v204 offset:38912
    v_mfma_f32_16x16x32_bf16 v[96:99], v[120:123], v[144:147], v[96:99]
    s_cmp_eq_u32 s20, 0
    s_cbranch_scc1 Lnon2
Lnon3:
    v_mfma_f32_16x16x32_bf16 v[100:103], v[120:123], v[148:151], v[100:103]
    s_setprio 0
    v_mfma_f32_16x16x32_bf16 v[108:111], v[124:127], v[148:151], v[108:111]
    v_mfma_f32_16x16x32_bf16 v[104:107], v[124:127], v[144:147], v[104:107]
    v_mfma_f32_16x16x32_bf16 v[76:79], v[140:143], v[124:127], v[76:79]
    v_mfma_f32_16x16x32_bf16 v[72:75], v[136:139], v[124:127], v[72:75]
    v_mfma_f32_16x16x32_bf16 v[44:47], v[132:135], v[124:127], v[44:47]
    v_mfma_f32_16x16x32_bf16 v[40:43], v[128:131], v[124:127], v[40:43]
    s_waitcnt vmcnt(1) lgkmcnt(0)
    s_barrier
    s_setprio 0
    s_cmp_lg_u32 s43, 0
    s_cbranch_scc1 Lp1_lo
    s_setprio 3
Lp1_lo:
    v_mfma_f32_16x16x32_bf16 v[16:19], v[168:171], v[152:155], v[16:19]
    ds_read_b128 v[112:115], v203 offset:49152
    s_lshl_b32 s27, s68, 1
    v_mfma_f32_16x16x32_bf16 v[20:23], v[172:175], v[152:155], v[20:23]
    ds_read_b64_tr_b16 v[128:129], v205 offset:8192
    v_mfma_f32_16x16x32_bf16 v[48:51], v[176:179], v[152:155], v[48:51]
    ds_read_b64_tr_b16 v[130:131], v205 offset:8704
    s_add_u32 s27, s27, s43
    v_mfma_f32_16x16x32_bf16 v[52:55], v[180:183], v[152:155], v[52:55]
    ds_read_b64_tr_b16 v[132:133], v206 offset:8192
    v_mfma_f32_16x16x32_bf16 v[80:83], v[152:155], v[184:187], v[80:83]
    ds_read_b64_tr_b16 v[134:135], v206 offset:8704
    v_mfma_f32_16x16x32_bf16 v[84:87], v[152:155], v[188:191], v[84:87]
    ds_read_b128 v[116:119], v203 offset:51200
    s_lshl_b32 s27, s27, 17
    v_mfma_f32_16x16x32_bf16 v[92:95], v[156:159], v[188:191], v[92:95]
    ds_read_b64_tr_b16 v[136:137], v205 offset:24576
    v_mfma_f32_16x16x32_bf16 v[88:91], v[156:159], v[184:187], v[88:91]
    ds_read_b64_tr_b16 v[138:139], v205 offset:25088
    v_mfma_f32_16x16x32_bf16 v[60:63], v[180:183], v[156:159], v[60:63]
    ds_read_b64_tr_b16 v[140:141], v206 offset:24576
    s_add_u32 s27, s27, 8388608
    v_mfma_f32_16x16x32_bf16 v[56:59], v[176:179], v[156:159], v[56:59]
    ds_read_b64_tr_b16 v[142:143], v206 offset:25088
    v_mfma_f32_16x16x32_bf16 v[28:31], v[172:175], v[156:159], v[28:31]
    ds_read_b128 v[120:123], v203 offset:53248
    v_mfma_f32_16x16x32_bf16 v[24:27], v[168:171], v[156:159], v[24:27]
    ds_read_b64_tr_b16 v[144:145], v205 offset:40960
    s_add_u32 s16, s62, s27
    s_addc_u32 s17, s63, 0
    v_mfma_f32_16x16x32_bf16 v[32:35], v[168:171], v[160:163], v[32:35]
    ds_read_b64_tr_b16 v[146:147], v205 offset:41472
    v_mfma_f32_16x16x32_bf16 v[36:39], v[172:175], v[160:163], v[36:39]
    ds_read_b64_tr_b16 v[148:149], v206 offset:40960
    v_mfma_f32_16x16x32_bf16 v[64:67], v[176:179], v[160:163], v[64:67]
    ds_read_b64_tr_b16 v[150:151], v206 offset:41472
    s_mov_b32 s18, 0x20000
    v_mfma_f32_16x16x32_bf16 v[68:71], v[180:183], v[160:163], v[68:71]
    ds_read_b128 v[124:127], v203 offset:55296
    v_mfma_f32_16x16x32_bf16 v[96:99], v[160:163], v[184:187], v[96:99]
    v_mfma_f32_16x16x32_bf16 v[100:103], v[160:163], v[188:191], v[100:103]
    s_movk_i32 s10, 2048
    v_mfma_f32_16x16x32_bf16 v[108:111], v[164:167], v[188:191], v[108:111]
    v_mfma_f32_16x16x32_bf16 v[104:107], v[164:167], v[184:187], v[104:107]
    v_mfma_f32_16x16x32_bf16 v[76:79], v[180:183], v[164:167], v[76:79]
    s_cmp_eq_u32 s43, 0
    s_cselect_b32 s8, s56, s62
    s_cselect_b32 s9, s57, s63
    s_cselect_b32 s10, s10, s14
    s_cbranch_scc0 Lgpf
    buffer_load_dword v207, v14, s[8:11], 0 offen
Lgpf:
    v_mfma_f32_16x16x32_bf16 v[72:75], v[176:179], v[164:167], v[72:75]
    v_mfma_f32_16x16x32_bf16 v[44:47], v[172:175], v[164:167], v[44:47]
    v_mfma_f32_16x16x32_bf16 v[40:43], v[168:171], v[164:167], v[40:43]
    s_waitcnt lgkmcnt(0)
    v_mfma_f32_16x16x32_bf16 v[16:19], v[128:131], v[112:115], v[16:19]
    ds_read_b128 v[152:155], v204 offset:49152
    v_mfma_f32_16x16x32_bf16 v[20:23], v[132:135], v[112:115], v[20:23]
    ds_read_b64_tr_b16 v[168:169], v205 offset:12288
    v_mfma_f32_16x16x32_bf16 v[48:51], v[136:139], v[112:115], v[48:51]
    ds_read_b64_tr_b16 v[170:171], v205 offset:12800
    v_mfma_f32_16x16x32_bf16 v[52:55], v[140:143], v[112:115], v[52:55]
    ds_read_b64_tr_b16 v[172:173], v206 offset:12288
    v_mfma_f32_16x16x32_bf16 v[80:83], v[112:115], v[144:147], v[80:83]
    ds_read_b64_tr_b16 v[174:175], v206 offset:12800
    v_mfma_f32_16x16x32_bf16 v[84:87], v[112:115], v[148:151], v[84:87]
    ds_read_b128 v[156:159], v204 offset:51200
    v_mfma_f32_16x16x32_bf16 v[92:95], v[116:119], v[148:151], v[92:95]
    ds_read_b64_tr_b16 v[176:177], v205 offset:28672
    v_mfma_f32_16x16x32_bf16 v[88:91], v[116:119], v[144:147], v[88:91]
    ds_read_b64_tr_b16 v[178:179], v205 offset:29184
    v_mfma_f32_16x16x32_bf16 v[60:63], v[140:143], v[116:119], v[60:63]
    ds_read_b64_tr_b16 v[180:181], v206 offset:28672
    v_mfma_f32_16x16x32_bf16 v[56:59], v[136:139], v[116:119], v[56:59]
    ds_read_b64_tr_b16 v[182:183], v206 offset:29184
    v_mfma_f32_16x16x32_bf16 v[28:31], v[132:135], v[116:119], v[28:31]
    ds_read_b128 v[160:163], v204 offset:53248
    v_mfma_f32_16x16x32_bf16 v[24:27], v[128:131], v[116:119], v[24:27]
    ds_read_b64_tr_b16 v[184:185], v205 offset:45056
    v_mfma_f32_16x16x32_bf16 v[32:35], v[128:131], v[120:123], v[32:35]
    ds_read_b64_tr_b16 v[186:187], v205 offset:45568
    v_mfma_f32_16x16x32_bf16 v[36:39], v[132:135], v[120:123], v[36:39]
    ds_read_b64_tr_b16 v[188:189], v206 offset:45056
    v_mfma_f32_16x16x32_bf16 v[64:67], v[136:139], v[120:123], v[64:67]
    ds_read_b64_tr_b16 v[190:191], v206 offset:45568
    v_mfma_f32_16x16x32_bf16 v[68:71], v[140:143], v[120:123], v[68:71]
    ds_read_b128 v[164:167], v204 offset:55296
    v_mfma_f32_16x16x32_bf16 v[96:99], v[120:123], v[144:147], v[96:99]
    v_mfma_f32_16x16x32_bf16 v[100:103], v[120:123], v[148:151], v[100:103]
    v_mfma_f32_16x16x32_bf16 v[108:111], v[124:127], v[148:151], v[108:111]
    v_mfma_f32_16x16x32_bf16 v[104:107], v[124:127], v[144:147], v[104:107]
    v_mfma_f32_16x16x32_bf16 v[76:79], v[140:143], v[124:127], v[76:79]
    v_mfma_f32_16x16x32_bf16 v[72:75], v[136:139], v[124:127], v[72:75]
    v_mfma_f32_16x16x32_bf16 v[44:47], v[132:135], v[124:127], v[44:47]
    v_mfma_f32_16x16x32_bf16 v[40:43], v[128:131], v[124:127], v[40:43]
    s_waitcnt lgkmcnt(0)
    ds_read_b32 v13, v11 offset:4
    s_cmp_lg_u32 s43, 0
    s_cbranch_scc1 Lepi_b
    v_mfma_f32_16x16x32_bf16 v[48:51], v[176:179], v[152:155], v[48:51]
    v_mfma_f32_16x16x32_bf16 v[52:55], v[180:183], v[152:155], v[52:55]
    v_mfma_f32_16x16x32_bf16 v[56:59], v[176:179], v[156:159], v[56:59]
    v_mfma_f32_16x16x32_bf16 v[60:63], v[180:183], v[156:159], v[60:63]
    v_mfma_f32_16x16x32_bf16 v[64:67], v[176:179], v[160:163], v[64:67]
    v_mfma_f32_16x16x32_bf16 v[68:71], v[180:183], v[160:163], v[68:71]
    v_mfma_f32_16x16x32_bf16 v[72:75], v[176:179], v[164:167], v[72:75]
    v_mfma_f32_16x16x32_bf16 v[76:79], v[180:183], v[164:167], v[76:79]
    v_mfma_f32_16x16x32_bf16 v[80:83], v[152:155], v[184:187], v[80:83]
    v_mfma_f32_16x16x32_bf16 v[88:91], v[156:159], v[184:187], v[88:91]
    v_cvt_pk_bf16_f32 v112, v48, v49
    v_cvt_pk_bf16_f32 v113, v50, v51
    v_cvt_pk_bf16_f32 v114, v52, v53
    v_cvt_pk_bf16_f32 v115, v54, v55
    buffer_store_dwordx4 v[112:115], v239, s[12:15], s30 offen offset:0 sc1
    v_mfma_f32_16x16x32_bf16 v[84:87], v[152:155], v[188:191], v[84:87]
    v_mfma_f32_16x16x32_bf16 v[92:95], v[156:159], v[188:191], v[92:95]
    v_cvt_pk_bf16_f32 v116, v56, v57
    v_cvt_pk_bf16_f32 v117, v58, v59
    v_cvt_pk_bf16_f32 v118, v60, v61
    v_cvt_pk_bf16_f32 v119, v62, v63
    buffer_store_dwordx4 v[116:119], v239, s[12:15], s30 offen offset:128 sc1
    v_mfma_f32_16x16x32_bf16 v[96:99], v[160:163], v[184:187], v[96:99]
    v_mfma_f32_16x16x32_bf16 v[104:107], v[164:167], v[184:187], v[104:107]
    v_cvt_pk_bf16_f32 v120, v64, v65
    v_cvt_pk_bf16_f32 v121, v66, v67
    v_cvt_pk_bf16_f32 v122, v68, v69
    v_cvt_pk_bf16_f32 v123, v70, v71
    buffer_store_dwordx4 v[120:123], v239, s[12:15], s69 offen offset:0 sc1
    v_mfma_f32_16x16x32_bf16 v[100:103], v[160:163], v[188:191], v[100:103]
    v_mfma_f32_16x16x32_bf16 v[108:111], v[164:167], v[188:191], v[108:111]
    v_cvt_pk_bf16_f32 v124, v72, v73
    v_cvt_pk_bf16_f32 v125, v74, v75
    v_cvt_pk_bf16_f32 v126, v76, v77
    v_cvt_pk_bf16_f32 v127, v78, v79
    buffer_store_dwordx4 v[124:127], v239, s[12:15], s69 offen offset:128 sc1
    v_mfma_f32_16x16x32_bf16 v[16:19], v[168:171], v[152:155], v[16:19]
    v_mfma_f32_16x16x32_bf16 v[20:23], v[172:175], v[152:155], v[20:23]
    v_cvt_pk_bf16_f32 v128, v80, v81
    v_cvt_pk_bf16_f32 v129, v82, v83
    v_cvt_pk_bf16_f32 v130, v88, v89
    v_cvt_pk_bf16_f32 v131, v90, v91
    buffer_store_dwordx4 v[128:131], v238, s[12:15], s30 offen offset:2048 sc1
    v_mfma_f32_16x16x32_bf16 v[24:27], v[168:171], v[156:159], v[24:27]
    v_mfma_f32_16x16x32_bf16 v[28:31], v[172:175], v[156:159], v[28:31]
    v_cvt_pk_bf16_f32 v132, v84, v85
    v_cvt_pk_bf16_f32 v133, v86, v87
    v_cvt_pk_bf16_f32 v134, v92, v93
    v_cvt_pk_bf16_f32 v135, v94, v95
    buffer_store_dwordx4 v[132:135], v238, s[12:15], s30 offen offset:2304 sc1
    v_mfma_f32_16x16x32_bf16 v[32:35], v[168:171], v[160:163], v[32:35]
    v_mfma_f32_16x16x32_bf16 v[36:39], v[172:175], v[160:163], v[36:39]
    v_cvt_pk_bf16_f32 v136, v96, v97
    v_cvt_pk_bf16_f32 v137, v98, v99
    v_cvt_pk_bf16_f32 v138, v104, v105
    v_cvt_pk_bf16_f32 v139, v106, v107
    buffer_store_dwordx4 v[136:139], v238, s[12:15], s69 offen offset:2048 sc1
    v_mfma_f32_16x16x32_bf16 v[40:43], v[168:171], v[164:167], v[40:43]
    v_mfma_f32_16x16x32_bf16 v[44:47], v[172:175], v[164:167], v[44:47]
    v_cvt_pk_bf16_f32 v140, v100, v101
    v_cvt_pk_bf16_f32 v141, v102, v103
    v_cvt_pk_bf16_f32 v142, v108, v109
    v_cvt_pk_bf16_f32 v143, v110, v111
    buffer_store_dwordx4 v[140:143], v238, s[12:15], s69 offen offset:2304 sc1
    s_nop 1
    v_pk_mul_f32 v[16:17], v[16:17], v[226:227]
    v_pk_mul_f32 v[18:19], v[18:19], v[226:227]
    v_pk_mul_f32 v[20:21], v[20:21], v[226:227]
    v_pk_mul_f32 v[22:23], v[22:23], v[226:227]
    v_pk_mul_f32 v[24:25], v[24:25], v[226:227]
    v_pk_mul_f32 v[26:27], v[26:27], v[226:227]
    v_pk_mul_f32 v[28:29], v[28:29], v[226:227]
    v_pk_mul_f32 v[30:31], v[30:31], v[226:227]
    v_pk_mul_f32 v[32:33], v[32:33], v[226:227]
    v_pk_mul_f32 v[34:35], v[34:35], v[226:227]
    v_pk_mul_f32 v[36:37], v[36:37], v[226:227]
    v_pk_mul_f32 v[38:39], v[38:39], v[226:227]
    v_pk_mul_f32 v[40:41], v[40:41], v[226:227]
    v_pk_mul_f32 v[42:43], v[42:43], v[226:227]
    v_pk_mul_f32 v[44:45], v[44:45], v[226:227]
    v_pk_mul_f32 v[46:47], v[46:47], v[226:227]
    v_cvt_pk_bf16_f32 v112, v16, v17
    v_cvt_pk_bf16_f32 v113, v18, v19
    v_cvt_pk_bf16_f32 v114, v20, v21
    v_cvt_pk_bf16_f32 v115, v22, v23
    ds_write_b128 v240, v[112:115] offset:0
    v_cvt_pk_bf16_f32 v116, v24, v25
    v_cvt_pk_bf16_f32 v117, v26, v27
    v_cvt_pk_bf16_f32 v118, v28, v29
    v_cvt_pk_bf16_f32 v119, v30, v31
    ds_write_b128 v240, v[116:119] offset:256
    v_cvt_pk_bf16_f32 v120, v32, v33
    v_cvt_pk_bf16_f32 v121, v34, v35
    v_cvt_pk_bf16_f32 v122, v36, v37
    v_cvt_pk_bf16_f32 v123, v38, v39
    ds_write_b128 v240, v[120:123] offset:2048
    v_cvt_pk_bf16_f32 v124, v40, v41
    v_cvt_pk_bf16_f32 v125, v42, v43
    v_cvt_pk_bf16_f32 v126, v44, v45
    v_cvt_pk_bf16_f32 v127, v46, v47
    ds_write_b128 v240, v[124:127] offset:2304
    buffer_load_dwordx4 v[160:163], v14, s[8:11], 0 offen
    buffer_load_dwordx4 v[164:167], v14, s[8:11], 0 offen offset:16
    buffer_load_dwordx4 v[144:147], v14, s[4:7], s26 offen
    buffer_load_dwordx4 v[148:151], v14, s[4:7], s26 offen offset:16
    buffer_load_dwordx4 v[152:155], v14, s[4:7], s26 offen offset:2048
    buffer_load_dwordx4 v[156:159], v14, s[4:7], s26 offen offset:2064
    v_mov_b32 v9, 1
    s_setprio 0
    s_waitcnt lgkmcnt(0)
    v_readfirstlane_b32 s98, v13
    s_mov_b32 s8, s48
    s_mov_b32 s9, s49
    s_mov_b32 s10, 0x200000
    s_barrier
    s_waitcnt vmcnt(6)
    s_mov_b64 exec, 1
    ds_add_rtn_u32 v9, v11, v9
    s_waitcnt lgkmcnt(0)
    v_readfirstlane_b32 s26, v9
    s_mov_b64 exec, -1
    s_cmp_lg_u32 s26, 3
    s_cbranch_scc1 Lepi_join
    s_add_u32 s36, s98, 1
    v_mov_b32 v9, s36
    s_mov_b64 exec, 1
    buffer_store_dword v9, off, s[12:15], s99 sc1
    s_mov_b64 exec, -1
    s_branch Lepi_join
Lepi_b:
    v_mfma_f32_16x16x32_bf16 v[16:19], v[168:171], v[152:155], v[16:19]
    v_mfma_f32_16x16x32_bf16 v[20:23], v[172:175], v[152:155], v[20:23]
    v_mfma_f32_16x16x32_bf16 v[48:51], v[176:179], v[152:155], v[48:51]
    v_mfma_f32_16x16x32_bf16 v[52:55], v[180:183], v[152:155], v[52:55]
    v_mfma_f32_16x16x32_bf16 v[80:83], v[152:155], v[184:187], v[80:83]
    v_mfma_f32_16x16x32_bf16 v[84:87], v[152:155], v[188:191], v[84:87]
    v_mfma_f32_16x16x32_bf16 v[92:95], v[156:159], v[188:191], v[92:95]
    v_mfma_f32_16x16x32_bf16 v[88:91], v[156:159], v[184:187], v[88:91]
    v_mfma_f32_16x16x32_bf16 v[60:63], v[180:183], v[156:159], v[60:63]
    v_mfma_f32_16x16x32_bf16 v[56:59], v[176:179], v[156:159], v[56:59]
    v_mfma_f32_16x16x32_bf16 v[28:31], v[172:175], v[156:159], v[28:31]
    v_mfma_f32_16x16x32_bf16 v[24:27], v[168:171], v[156:159], v[24:27]
    v_mfma_f32_16x16x32_bf16 v[32:35], v[168:171], v[160:163], v[32:35]
    v_mfma_f32_16x16x32_bf16 v[36:39], v[172:175], v[160:163], v[36:39]
    v_mfma_f32_16x16x32_bf16 v[64:67], v[176:179], v[160:163], v[64:67]
    v_mfma_f32_16x16x32_bf16 v[68:71], v[180:183], v[160:163], v[68:71]
    v_mfma_f32_16x16x32_bf16 v[96:99], v[160:163], v[184:187], v[96:99]
    v_mfma_f32_16x16x32_bf16 v[100:103], v[160:163], v[188:191], v[100:103]
    v_mfma_f32_16x16x32_bf16 v[108:111], v[164:167], v[188:191], v[108:111]
    v_mfma_f32_16x16x32_bf16 v[104:107], v[164:167], v[184:187], v[104:107]
    v_mfma_f32_16x16x32_bf16 v[76:79], v[180:183], v[164:167], v[76:79]
    v_mfma_f32_16x16x32_bf16 v[72:75], v[176:179], v[164:167], v[72:75]
    v_mfma_f32_16x16x32_bf16 v[44:47], v[172:175], v[164:167], v[44:47]
    v_mfma_f32_16x16x32_bf16 v[40:43], v[168:171], v[164:167], v[40:43]
    s_nop 7
    v_cvt_pk_bf16_f32 v128, v72, v73
    v_cvt_pk_bf16_f32 v129, v74, v75
    v_cvt_pk_bf16_f32 v130, v76, v77
    v_cvt_pk_bf16_f32 v131, v78, v79
    v_cvt_pk_bf16_f32 v196, v104, v105
    v_cvt_pk_bf16_f32 v197, v106, v107
    v_cvt_pk_bf16_f32 v198, v108, v109
    v_cvt_pk_bf16_f32 v199, v110, v111
    s_cmp_eq_u32 s41, 0
    s_cbranch_scc1 Lepi_b0
    buffer_store_dwordx4 v[128:131], v12, s[12:15], s25 offen sc1
    buffer_store_dwordx4 v[196:199], v12, s[12:15], s25 offen offset:1024 sc1
    s_branch Lepi_b1
Lepi_b0:
    ds_write_b128 v243, v[128:131]
    ds_write_b128 v243, v[196:199] offset:1024
Lepi_b1:
    v_cvt_pk_bf16_f32 v116, v48, v49
    v_cvt_pk_bf16_f32 v117, v50, v51
    v_cvt_pk_bf16_f32 v118, v52, v53
    v_cvt_pk_bf16_f32 v119, v54, v55
    v_cvt_pk_bf16_f32 v120, v56, v57
    v_cvt_pk_bf16_f32 v121, v58, v59
    v_cvt_pk_bf16_f32 v122, v60, v61
    v_cvt_pk_bf16_f32 v123, v62, v63
    v_cvt_pk_bf16_f32 v124, v64, v65
    v_cvt_pk_bf16_f32 v125, v66, v67
    v_cvt_pk_bf16_f32 v126, v68, v69
    v_cvt_pk_bf16_f32 v127, v70, v71
    v_cvt_pk_bf16_f32 v150, v80, v81
    v_cvt_pk_bf16_f32 v151, v82, v83
    v_cvt_pk_bf16_f32 v160, v84, v85
    v_cvt_pk_bf16_f32 v161, v86, v87
    v_cvt_pk_bf16_f32 v152, v88, v89
    v_cvt_pk_bf16_f32 v153, v90, v91
    v_cvt_pk_bf16_f32 v162, v92, v93
    v_cvt_pk_bf16_f32 v163, v94, v95
    v_cvt_pk_bf16_f32 v154, v96, v97
    v_cvt_pk_bf16_f32 v155, v98, v99
    v_cvt_pk_bf16_f32 v164, v100, v101
    v_cvt_pk_bf16_f32 v165, v102, v103
    v_cvt_pk_bf16_f32 v156, v104, v105
    v_cvt_pk_bf16_f32 v157, v106, v107
    v_cvt_pk_bf16_f32 v166, v108, v109
    v_cvt_pk_bf16_f32 v167, v110, v111
    v_pk_mul_f32 v[16:17], v[16:17], v[226:227]
    v_pk_mul_f32 v[18:19], v[18:19], v[226:227]
    v_pk_mul_f32 v[20:21], v[20:21], v[226:227]
    v_pk_mul_f32 v[22:23], v[22:23], v[226:227]
    v_pk_mul_f32 v[24:25], v[24:25], v[226:227]
    v_pk_mul_f32 v[26:27], v[26:27], v[226:227]
    v_pk_mul_f32 v[28:29], v[28:29], v[226:227]
    v_pk_mul_f32 v[30:31], v[30:31], v[226:227]
    v_pk_mul_f32 v[32:33], v[32:33], v[226:227]
    v_pk_mul_f32 v[34:35], v[34:35], v[226:227]
    v_pk_mul_f32 v[36:37], v[36:37], v[226:227]
    v_pk_mul_f32 v[38:39], v[38:39], v[226:227]
    v_pk_mul_f32 v[40:41], v[40:41], v[226:227]
    v_pk_mul_f32 v[42:43], v[42:43], v[226:227]
    v_pk_mul_f32 v[44:45], v[44:45], v[226:227]
    v_pk_mul_f32 v[46:47], v[46:47], v[226:227]
    v_cvt_pk_bf16_f32 v132, v16, v17
    v_cvt_pk_bf16_f32 v133, v18, v19
    v_cvt_pk_bf16_f32 v134, v20, v21
    v_cvt_pk_bf16_f32 v135, v22, v23
    v_cvt_pk_bf16_f32 v136, v24, v25
    v_cvt_pk_bf16_f32 v137, v26, v27
    v_cvt_pk_bf16_f32 v138, v28, v29
    v_cvt_pk_bf16_f32 v139, v30, v31
    v_cvt_pk_bf16_f32 v140, v32, v33
    v_cvt_pk_bf16_f32 v141, v34, v35
    v_cvt_pk_bf16_f32 v142, v36, v37
    v_cvt_pk_bf16_f32 v143, v38, v39
    v_cvt_pk_bf16_f32 v144, v40, v41
    v_cvt_pk_bf16_f32 v145, v42, v43
    v_cvt_pk_bf16_f32 v146, v44, v45
    v_cvt_pk_bf16_f32 v147, v46, v47
    v_lshlrev_b32 v196, 2, v237
    v_sub_u32 v196, v236, v196
    v_mov_b32 v197, 0xf149f2ca
    v_bfrev_b32 v200, 1
    v_subrev_u32 v198, 0, v196
    v_and_b32 v199, 0x80000001, v198
    v_cmp_eq_u32 vcc, 0, v199
    v_cmp_eq_u32 s[26:27], v199, v200
    v_mov_b32 v176, 0x3f803f80
    v_cndmask_b32 v168, v197, 0, vcc
    v_cndmask_b32 v172, v197, 0, s[26:27]
    v_subrev_u32 v198, 1, v196
    v_and_b32 v199, 0x80000001, v198
    v_cmp_eq_u32 vcc, 0, v199
    v_cmp_eq_u32 s[26:27], v199, v200
    v_mov_b32 v177, 0x3f803f80
    v_cndmask_b32 v169, v197, 0, vcc
    v_cndmask_b32 v173, v197, 0, s[26:27]
    v_subrev_u32 v198, 2, v196
    v_and_b32 v199, 0x80000001, v198
    v_cmp_eq_u32 vcc, 0, v199
    v_cmp_eq_u32 s[26:27], v199, v200
    v_mov_b32 v178, 0x3f803f80
    v_cndmask_b32 v170, v197, 0, vcc
    v_cndmask_b32 v174, v197, 0, s[26:27]
    v_subrev_u32 v198, 3, v196
    v_and_b32 v199, 0x80000001, v198
    v_cmp_eq_u32 vcc, 0, v199
    v_cmp_eq_u32 s[26:27], v199, v200
    v_mov_b32 v179, 0x3f803f80
    v_cndmask_b32 v171, v197, 0, vcc
    v_cndmask_b32 v175, v197, 0, s[26:27]
    s_waitcnt lgkmcnt(0)
    v_readfirstlane_b32 s98, v13
    s_barrier
    s_cmp_eq_u32 s41, 0
    s_cbranch_scc1 Lepi_b2
    ds_read_b128 v[112:115], v243
    ds_read_b64 v[148:149], v243 offset:1024
    ds_read_b64 v[158:159], v243 offset:1032
Lepi_b2:
    v_mfma_f32_16x16x32_bf16 v[16:19], v[116:119], v[136:139], v[172:175]
    v_mfma_f32_16x16x32_bf16 v[20:23], v[120:123], v[136:139], v[168:171]
    v_mfma_f32_16x16x32_bf16 v[48:51], v[120:123], v[140:143], v[172:175]
    v_mfma_f32_16x16x32_bf16 v[52:55], v[124:127], v[140:143], v[168:171]
    v_mfma_f32_16x16x32_bf16 v[80:83], v[124:127], v[144:147], v[172:175]
    v_mfma_f32_16x16x32_bf16 v[84:87], v[128:131], v[144:147], v[168:171]
    s_nop 7
    v_max3_f32 v40, v16, v17, v18
    v_max3_f32 v72, v48, v49, v50
    v_max3_f32 v104, v80, v81, v82
    v_max3_f32 v40, v40, v19, v20
    v_max3_f32 v72, v72, v51, v52
    v_max3_f32 v104, v104, v83, v84
    v_max3_f32 v40, v40, v21, v22
    v_max3_f32 v72, v72, v53, v54
    v_max3_f32 v104, v104, v85, v86
    v_max_f32 v40, v40, v23
    v_max_f32 v72, v72, v55
    v_max_f32 v104, v104, v87
    v_mov_b32 v41, v40
    v_mov_b32 v73, v72
    v_mov_b32 v105, v104
    v_permlane16_swap_b32 v40, v41
    v_permlane16_swap_b32 v72, v73
    v_permlane16_swap_b32 v104, v105
    v_max_f32 v40, v40, v41
    v_max_f32 v72, v72, v73
    v_max_f32 v104, v104, v105
    v_mov_b32 v41, v40
    v_mov_b32 v73, v72
    v_mov_b32 v105, v104
    v_permlane32_swap_b32 v40, v41
    v_permlane32_swap_b32 v72, v73
    v_permlane32_swap_b32 v104, v105
    v_max_f32 v40, v40, v41
    v_max_f32 v72, v72, v73
    v_max_f32 v104, v104, v105
    v_sub_f32 v16, v16, v40
    v_sub_f32 v17, v17, v40
    v_sub_f32 v18, v18, v40
    v_sub_f32 v19, v19, v40
    v_sub_f32 v20, v20, v40
    v_sub_f32 v21, v21, v40
    v_sub_f32 v22, v22, v40
    v_sub_f32 v23, v23, v40
    v_sub_f32 v48, v48, v72
    v_sub_f32 v49, v49, v72
    v_sub_f32 v50, v50, v72
    v_sub_f32 v51, v51, v72
    v_sub_f32 v52, v52, v72
    v_sub_f32 v53, v53, v72
    v_sub_f32 v54, v54, v72
    v_sub_f32 v55, v55, v72
    v_sub_f32 v80, v80, v104
    v_sub_f32 v81, v81, v104
    v_sub_f32 v82, v82, v104
    v_sub_f32 v83, v83, v104
    v_sub_f32 v84, v84, v104
    v_sub_f32 v85, v85, v104
    v_sub_f32 v86, v86, v104
    v_sub_f32 v87, v87, v104
    v_exp_f32 v16, v16
    v_exp_f32 v17, v17
    v_exp_f32 v18, v18
    v_exp_f32 v19, v19
    v_exp_f32 v20, v20
    v_exp_f32 v21, v21
    v_exp_f32 v22, v22
    v_exp_f32 v23, v23
    v_exp_f32 v48, v48
    v_exp_f32 v49, v49
    v_exp_f32 v50, v50
    v_exp_f32 v51, v51
    v_exp_f32 v52, v52
    v_exp_f32 v53, v53
    v_exp_f32 v54, v54
    v_exp_f32 v55, v55
    v_exp_f32 v80, v80
    v_exp_f32 v81, v81
    v_exp_f32 v82, v82
    v_exp_f32 v83, v83
    v_exp_f32 v84, v84
    v_exp_f32 v85, v85
    v_exp_f32 v86, v86
    v_exp_f32 v87, v87
    s_nop 0
    v_cvt_pk_bf16_f32 v24, v16, v17
    v_cvt_pk_bf16_f32 v25, v18, v19
    v_cvt_pk_bf16_f32 v26, v20, v21
    v_cvt_pk_bf16_f32 v27, v22, v23
    v_cvt_pk_bf16_f32 v56, v48, v49
    v_cvt_pk_bf16_f32 v57, v50, v51
    v_cvt_pk_bf16_f32 v58, v52, v53
    v_cvt_pk_bf16_f32 v59, v54, v55
    v_cvt_pk_bf16_f32 v88, v80, v81
    v_cvt_pk_bf16_f32 v89, v82, v83
    v_cvt_pk_bf16_f32 v90, v84, v85
    v_cvt_pk_bf16_f32 v91, v86, v87
    s_nop 1
    v_mfma_f32_16x16x32_bf16 v[36:39], v[176:179], v[24:27], 0
    v_mfma_f32_16x16x32_bf16 v[28:31], v[150:153], v[24:27], 0
    v_mfma_f32_16x16x32_bf16 v[32:35], v[160:163], v[24:27], 0
    v_mfma_f32_16x16x32_bf16 v[68:71], v[176:179], v[56:59], 0
    v_mfma_f32_16x16x32_bf16 v[60:63], v[152:155], v[56:59], 0
    v_mfma_f32_16x16x32_bf16 v[64:67], v[162:165], v[56:59], 0
    v_mfma_f32_16x16x32_bf16 v[100:103], v[176:179], v[88:91], 0
    v_mfma_f32_16x16x32_bf16 v[92:95], v[154:157], v[88:91], 0
    v_mfma_f32_16x16x32_bf16 v[96:99], v[164:167], v[88:91], 0
    s_nop 7
    v_rcp_f32 v36, v36
    v_rcp_f32 v68, v68
    v_rcp_f32 v100, v100
    v_mul_f32 v28, v28, v36
    v_mul_f32 v29, v29, v36
    v_mul_f32 v30, v30, v36
    v_mul_f32 v31, v31, v36
    v_mul_f32 v32, v32, v36
    v_mul_f32 v33, v33, v36
    v_mul_f32 v34, v34, v36
    v_mul_f32 v35, v35, v36
    v_cvt_pk_bf16_f32 v144, v28, v29
    v_cvt_pk_bf16_f32 v145, v30, v31
    v_cvt_pk_bf16_f32 v146, v32, v33
    v_cvt_pk_bf16_f32 v147, v34, v35
    v_mul_f32 v60, v60, v68
    v_mul_f32 v61, v61, v68
    v_mul_f32 v62, v62, v68
    v_mul_f32 v63, v63, v68
    v_mul_f32 v64, v64, v68
    v_mul_f32 v65, v65, v68
    v_mul_f32 v66, v66, v68
    v_mul_f32 v67, v67, v68
    v_cvt_pk_bf16_f32 v152, v60, v61
    v_cvt_pk_bf16_f32 v153, v62, v63
    v_cvt_pk_bf16_f32 v154, v64, v65
    v_cvt_pk_bf16_f32 v155, v66, v67
    v_mul_f32 v92, v92, v100
    v_mul_f32 v93, v93, v100
    v_mul_f32 v94, v94, v100
    v_mul_f32 v95, v95, v100
    v_mul_f32 v96, v96, v100
    v_mul_f32 v97, v97, v100
    v_mul_f32 v98, v98, v100
    v_mul_f32 v99, v99, v100
    v_cvt_pk_bf16_f32 v162, v92, v93
    v_cvt_pk_bf16_f32 v163, v94, v95
    v_cvt_pk_bf16_f32 v164, v96, v97
    v_cvt_pk_bf16_f32 v165, v98, v99
    s_cmp_eq_u32 s41, 0
    s_cbranch_scc1 Lepi_join
    s_waitcnt vmcnt(0) lgkmcnt(0)
    s_add_u32 s36, s98, 1
    v_mov_b32 v9, s36
    s_mov_b64 exec, 1
    buffer_store_dword v9, off, s[12:15], s47 sc1
    s_mov_b64 exec, -1
Lepi_join:
    ds_read_b128 v[180:183], v241
    ds_read_b128 v[184:187], v241 offset:1024
    ds_read_b128 v[188:191], v242
    ds_read_b128 v[192:195], v242 offset:1024
    v_mov_b64 v[104:105], v[228:229]
    v_mov_b64 v[106:107], v[230:231]
    v_mov_b64 v[108:109], v[232:233]
    v_mov_b64 v[110:111], v[234:235]
    v_mov_b64 v[16:17], 0
    v_mov_b64 v[18:19], 0
    v_mov_b64 v[20:21], 0
    v_mov_b64 v[22:23], 0
    v_mov_b64 v[24:25], 0
    v_mov_b64 v[26:27], 0
    v_mov_b64 v[28:29], 0
    v_mov_b64 v[30:31], 0
    v_mov_b64 v[32:33], 0
    v_mov_b64 v[34:35], 0
    v_mov_b64 v[36:37], 0
    v_mov_b64 v[38:39], 0
    v_mov_b64 v[40:41], 0
    v_mov_b64 v[42:43], 0
    v_mov_b64 v[44:45], 0
    v_mov_b64 v[46:47], 0
    v_mov_b64 v[48:49], 0
    v_mov_b64 v[50:51], 0
    v_mov_b64 v[52:53], 0
    v_mov_b64 v[54:55], 0
    v_mov_b64 v[96:97], 0
    v_mov_b64 v[98:99], 0
    v_mov_b64 v[100:101], 0
    v_mov_b64 v[102:103], 0
    v_mov_b64 v[136:137], 0
    v_mov_b64 v[138:139], 0
    v_mov_b64 v[140:141], 0
    v_mov_b64 v[142:143], 0
    s_mov_b32 s36, 524288
Lownb:
    ds_read_b32 v9, v11 offset:0
    s_waitcnt lgkmcnt(0)
    v_readfirstlane_b32 s26, v9
    s_sub_u32 s36, s36, 1
    s_cselect_b32 s26, 4, s26
    s_cmp_ge_u32 s26, 4
    s_cbranch_scc1 Lownc
    s_sleep 1
    s_branch Lownb
Lownc:
    s_mov_b32 s30, s40
    s_add_u32 s57, s40, 4096
    buffer_load_dwordx4 v[196:199], v12, s[16:19], s30 offen offset:0
    buffer_load_dwordx4 v[200:203], v12, s[16:19], s30 offen offset:1024
    buffer_load_dwordx4 v[220:223], v12, s[16:19], s30 offen offset:2048
    buffer_load_dwordx4 v[224:227], v12, s[16:19], s30 offen offset:3072
    buffer_load_dwordx4 v[204:207], v12, s[16:19], s57 offen offset:0
    buffer_load_dwordx4 v[208:211], v12, s[16:19], s57 offen offset:1024
    buffer_load_dwordx4 v[228:231], v12, s[16:19], s57 offen offset:2048
    buffer_load_dwordx4 v[232:235], v12, s[16:19], s57 offen offset:3072
    s_mov_b32 s75, s25
    s_andn2_b32 s99, s99, 255
    s_add_u32 s28, s98, 1
    s_cmp_lg_u32 s20, 0
    s_cbranch_scc1 Lgo0
    v_mov_b32 v9, 0
    ds_write_b32 v10, v9
    ds_write_b32 v10, v9 offset:4
Lgo0:
    s_sub_u32 s75, s75, 4096
    s_and_b32 s26, s20, 5
    s_cmp_lg_u32 s26, 4
    s_cselect_b32 s75, 0, s75
    s_cmp_eq_u32 s22, 0
    s_cselect_b32 s75, 0, s75
    s_sub_u32 s27, s47, 128
    s_waitcnt vmcnt(6)
    v_mfma_f32_32x32x16_bf16 v[56:71], v[196:199], v[180:183], 0
    v_mfma_f32_32x32x16_bf16 v[56:71], v[200:203], v[184:187], v[56:71]
    s_mov_b32 s37, 7
    s_nop 10
    v_mfma_f32_32x32x16_bf16 v[72:87], v[196:199], v[188:191], 0
    v_exp_f32 v56, v56
    v_exp_f32 v57, v57
    v_exp_f32 v58, v58
    v_exp_f32 v59, v59
    v_cvt_pk_bf16_f32 v88, v56, v57
    v_mfma_f32_32x32x16_bf16 v[72:87], v[200:203], v[192:195], v[72:87]
    v_exp_f32 v60, v60
    v_exp_f32 v61, v61
    v_cvt_pk_bf16_f32 v89, v58, v59
    v_exp_f32 v62, v62
    v_exp_f32 v63, v63
    v_cvt_pk_bf16_f32 v90, v60, v61
    v_mfma_f32_32x32x16_bf16 v[32:47], v[136:139], v[96:99], v[32:47]
    v_exp_f32 v64, v64
    v_exp_f32 v65, v65
    v_cvt_pk_bf16_f32 v91, v62, v63
    v_exp_f32 v66, v66
    v_exp_f32 v67, v67
    v_mfma_f32_32x32x16_bf16 v[32:47], v[140:143], v[100:103], v[32:47]
    v_cvt_pk_bf16_f32 v92, v64, v65
    v_exp_f32 v68, v68
    v_exp_f32 v69, v69
    v_cvt_pk_bf16_f32 v93, v66, v67
    v_exp_f32 v70, v70
    v_smfmac_f32_16x16x64_bf16 v[52:55], v[244:247], v[96:103], v248
    s_waitcnt vmcnt(2)
    v_exp_f32 v71, v71
    v_cvt_pk_bf16_f32 v94, v68, v69
    v_cvt_pk_bf16_f32 v95, v70, v71
    v_mfma_f32_32x32x16_bf16 v[56:71], v[204:207], v[180:183], 0
    v_exp_f32 v72, v72
    v_exp_f32 v73, v73
    v_exp_f32 v74, v74
    v_exp_f32 v75, v75
    v_cvt_pk_bf16_f32 v96, v72, v73
    v_mfma_f32_32x32x16_bf16 v[56:71], v[208:211], v[184:187], v[56:71]
    v_exp_f32 v76, v76
    v_exp_f32 v77, v77
    v_cvt_pk_bf16_f32 v97, v74, v75
    v_exp_f32 v78, v78
    v_exp_f32 v79, v79
    v_cvt_pk_bf16_f32 v98, v76, v77
    v_mfma_f32_32x32x16_bf16 v[16:31], v[220:223], v[88:91], v[16:31]
    v_exp_f32 v80, v80
    v_exp_f32 v81, v81
    v_cvt_pk_bf16_f32 v99, v78, v79
    v_exp_f32 v82, v82
    v_exp_f32 v83, v83
    v_mfma_f32_32x32x16_bf16 v[16:31], v[224:227], v[92:95], v[16:31]
    v_cvt_pk_bf16_f32 v100, v80, v81
    v_exp_f32 v84, v84
    v_exp_f32 v85, v85
    v_cvt_pk_bf16_f32 v101, v82, v83
    v_exp_f32 v86, v86
    v_smfmac_f32_16x16x64_bf16 v[48:51], v[244:247], v[88:95], v248
    v_exp_f32 v87, v87
    v_cvt_pk_bf16_f32 v102, v84, v85
    v_cvt_pk_bf16_f32 v103, v86, v87
    s_cmp_lg_u32 s20, 0
    s_cbranch_scc1 Lgo1
    buffer_load_dword v9, v8, s[12:15], s99 offen sc1
Lgo1:
    s_cmp_eq_u32 s75, 0
    s_cbranch_scc1 Lgo2
    buffer_load_dword v9, off, s[12:15], s27 sc1
Lgo2:
    v_mfma_f32_32x32x16_bf16 v[72:87], v[204:207], v[188:191], 0
    v_exp_f32 v56, v56
    v_exp_f32 v57, v57
    v_exp_f32 v58, v58
    v_exp_f32 v59, v59
    v_cvt_pk_bf16_f32 v88, v56, v57
    v_mfma_f32_32x32x16_bf16 v[72:87], v[208:211], v[192:195], v[72:87]
    v_exp_f32 v60, v60
    v_exp_f32 v61, v61
    v_cvt_pk_bf16_f32 v89, v58, v59
    v_exp_f32 v62, v62
    v_exp_f32 v63, v63
    v_cvt_pk_bf16_f32 v90, v60, v61
    v_mfma_f32_32x32x16_bf16 v[32:47], v[220:223], v[96:99], v[32:47]
    v_exp_f32 v64, v64
    v_exp_f32 v65, v65
    v_cvt_pk_bf16_f32 v91, v62, v63
    v_exp_f32 v66, v66
    v_exp_f32 v67, v67
    v_mfma_f32_32x32x16_bf16 v[32:47], v[224:227], v[100:103], v[32:47]
    v_cvt_pk_bf16_f32 v92, v64, v65
    v_exp_f32 v68, v68
    v_exp_f32 v69, v69
    v_cvt_pk_bf16_f32 v93, v66, v67
    v_exp_f32 v70, v70
    v_smfmac_f32_16x16x64_bf16 v[52:55], v[244:247], v[96:103], v248
    s_waitcnt vmcnt(0)
    v_exp_f32 v71, v71
    v_cvt_pk_bf16_f32 v94, v68, v69
    v_cvt_pk_bf16_f32 v95, v70, v71
    v_exp_f32 v72, v72
    v_exp_f32 v73, v73
    v_exp_f32 v74, v74
    v_exp_f32 v75, v75
    v_cvt_pk_bf16_f32 v96, v72, v73
    v_exp_f32 v76, v76
    v_exp_f32 v77, v77
    v_cvt_pk_bf16_f32 v97, v74, v75
    v_exp_f32 v78, v78
    v_exp_f32 v79, v79
    v_cvt_pk_bf16_f32 v98, v76, v77
    v_mfma_f32_32x32x16_bf16 v[16:31], v[228:231], v[88:91], v[16:31]
    v_exp_f32 v80, v80
    v_exp_f32 v81, v81
    v_cvt_pk_bf16_f32 v99, v78, v79
    v_exp_f32 v82, v82
    v_exp_f32 v83, v83
    v_mfma_f32_32x32x16_bf16 v[16:31], v[232:235], v[92:95], v[16:31]
    v_cvt_pk_bf16_f32 v100, v80, v81
    v_exp_f32 v84, v84
    v_exp_f32 v85, v85
    v_cvt_pk_bf16_f32 v101, v82, v83
    v_exp_f32 v86, v86
    v_smfmac_f32_16x16x64_bf16 v[48:51], v[244:247], v[88:95], v248
    v_exp_f32 v87, v87
    v_cvt_pk_bf16_f32 v102, v84, v85
    v_cvt_pk_bf16_f32 v103, v86, v87
    v_subrev_u32 v9, s28, v9
    v_cmp_ge_u32 vcc, 2, v9
    s_cmp_lg_u32 s20, 0
    s_cbranch_scc1 Lsync0
    s_cmp_eq_u64 vcc, -1
    s_cbranch_scc1 Lpoll1_ok
    s_mov_b32 s36, 65536
    s_add_u32 s28, s98, 1
Lpoll1:
    buffer_load_dword v9, v8, s[12:15], s99 offen sc1
    s_waitcnt vmcnt(0)
    v_subrev_u32 v9, s28, v9
    v_cmp_ge_u32 vcc, 2, v9
    s_sub_u32 s36, s36, 1
    s_cmp_eq_u64 vcc, -1
    s_cbranch_scc1 Lpoll1_ok
    s_sleep 2
    s_cmp_lg_u32 s36, 0
    s_cbranch_scc1 Lpoll1
Lpoll1_ok:
    v_mov_b32 v9, 1
    ds_write_b32 v11, v9 offset:8
    s_branch Lsync1c
Lsync0:
    s_cmp_eq_u32 s75, 0
    s_cbranch_scc1 Lsync1
    s_cmp_eq_u64 vcc, -1
    s_cbranch_scc1 Lpollh_ok
    s_mov_b32 s36, 65536
    s_add_u32 s28, s98, 1
Lpollh:
    buffer_load_dword v9, off, s[12:15], s27 sc1
    s_waitcnt vmcnt(0)
    v_subrev_u32 v9, s28, v9
    v_cmp_ge_u32 vcc, 2, v9
    s_sub_u32 s36, s36, 1
    s_cmp_eq_u64 vcc, -1
    s_cbranch_scc1 Lpollh_ok
    s_sleep 2
    s_cmp_lg_u32 s36, 0
    s_cbranch_scc1 Lpollh
Lpollh_ok:
    buffer_load_dwordx4 v[112:115], v12, s[12:15], s75 offen sc1
    buffer_load_dwordx2 v[148:149], v12, s[12:15], s75 offen offset:1024 sc1
    buffer_load_dwordx2 v[158:159], v12, s[12:15], s75 offen offset:1032 sc1
Lsync1:
    s_mov_b32 s36, 524288
Lsync1b:
    ds_read_b32 v9, v11 offset:8
    s_waitcnt lgkmcnt(0)
    v_readfirstlane_b32 s26, v9
    s_sub_u32 s36, s36, 1
    s_cselect_b32 s26, 1, s26
    s_cmp_ge_u32 s26, 1
    s_cbranch_scc1 Lsync1c
    s_sleep 1
    s_branch Lsync1b
Lsync1c:
    s_add_u32 s30, s57, 4096
    s_and_b32 s30, s30, 0x1ffff
    buffer_load_dwordx4 v[212:215], v12, s[16:19], s30 offen offset:0
    buffer_load_dwordx4 v[216:219], v12, s[16:19], s30 offen offset:1024
    s_add_u32 s57, s30, 4096
    s_and_b32 s57, s57, 0x1ffff
    buffer_load_dwordx4 v[120:123], v12, s[16:19], s57 offen offset:0
    buffer_load_dwordx4 v[124:127], v12, s[16:19], s57 offen offset:1024
    buffer_load_dwordx4 v[236:239], v12, s[16:19], s30 offen offset:2048
    buffer_load_dwordx4 v[240:243], v12, s[16:19], s30 offen offset:3072
    s_add_u32 s30, s57, 4096
    s_and_b32 s30, s30, 0x1ffff
    buffer_load_dwordx4 v[196:199], v12, s[16:19], s30 offen offset:0
    buffer_load_dwordx4 v[200:203], v12, s[16:19], s30 offen offset:1024
    buffer_load_dwordx4 v[136:139], v12, s[16:19], s57 offen offset:2048
    buffer_load_dwordx4 v[140:143], v12, s[16:19], s57 offen offset:3072
    s_add_u32 s57, s30, 4096
    s_and_b32 s57, s57, 0x1ffff
    s_cmp_ge_u32 s32, s39
    s_cselect_b32 m0, 0x30000, s32
    s_cselect_b32 s25, 0x40000000, s69
    s_add_u32 s32, s32, 4096
    buffer_load_dwordx4 v252, s[64:67], s25 offen lds
    buffer_load_dwordx4 v253, s[64:67], s25 offen offset:1024 lds
    s_add_u32 s69, s69, 65536
    buffer_load_dwordx4 v[204:207], v12, s[16:19], s57 offen offset:0
    buffer_load_dwordx4 v[208:211], v12, s[16:19], s57 offen offset:1024
    buffer_load_dwordx4 v[220:223], v12, s[16:19], s30 offen offset:2048
    buffer_load_dwordx4 v[224:227], v12, s[16:19], s30 offen offset:3072
    s_add_u32 s30, s57, 4096
    s_and_b32 s30, s30, 0x1ffff
    s_cmp_lt_u32 s20, 4
    s_cbranch_scc1 Lgate
    s_cmp_lg_u32 s41, 0
    s_cbranch_scc1 Lhalo1
    s_waitcnt vmcnt(16)
    s_cmp_lg_u32 s22, 0
    s_cbranch_scc1 Lhalo1
    v_mov_b64 v[112:113], 0
    v_mov_b64 v[114:115], 0
    v_mov_b64 v[148:149], 0
    v_mov_b64 v[158:159], 0
    v_mov_b32 v172, 0xf149f2ca
    v_mov_b32 v173, 0xf149f2ca
    v_mov_b32 v174, 0xf149f2ca
    v_mov_b32 v175, 0xf149f2ca
    s_nop 1
Lhalo1:
    v_mfma_f32_16x16x32_bf16 v[56:59], v[112:115], v[132:135], v[172:175]
    v_mfma_f32_16x16x32_bf16 v[60:63], v[116:119], v[132:135], v[168:171]
    s_nop 7
    v_max3_f32 v80, v56, v57, v58
    v_max3_f32 v80, v80, v59, v60
    v_max3_f32 v80, v80, v61, v62
    v_max_f32 v80, v80, v63
    v_mov_b32 v81, v80
    s_nop 1
    v_permlane16_swap_b32 v80, v81
    s_nop 0
    v_max_f32 v80, v80, v81
    v_mov_b32 v81, v80
    s_nop 1
    v_permlane32_swap_b32 v80, v81
    s_nop 0
    v_max_f32 v80, v80, v81
    v_sub_f32 v56, v56, v80
    v_sub_f32 v57, v57, v80
    v_sub_f32 v58, v58, v80
    v_sub_f32 v59, v59, v80
    v_sub_f32 v60, v60, v80
    v_sub_f32 v61, v61, v80
    v_sub_f32 v62, v62, v80
    v_sub_f32 v63, v63, v80
    v_exp_f32 v56, v56
    v_exp_f32 v57, v57
    v_exp_f32 v58, v58
    v_exp_f32 v59, v59
    v_exp_f32 v60, v60
    v_exp_f32 v61, v61
    v_exp_f32 v62, v62
    v_exp_f32 v63, v63
    s_nop 0
    v_cvt_pk_bf16_f32 v64, v56, v57
    v_cvt_pk_bf16_f32 v65, v58, v59
    v_cvt_pk_bf16_f32 v66, v60, v61
    v_cvt_pk_bf16_f32 v67, v62, v63
    s_nop 1
    v_mfma_f32_16x16x32_bf16 v[76:79], v[176:179], v[64:67], 0
    v_mfma_f32_16x16x32_bf16 v[68:71], v[148:151], v[64:67], 0
    v_mfma_f32_16x16x32_bf16 v[72:75], v[158:161], v[64:67], 0
    s_nop 7
    v_rcp_f32 v76, v76
    s_nop 0
    v_mul_f32 v68, v68, v76
    v_mul_f32 v69, v69, v76
    v_mul_f32 v70, v70, v76
    v_mul_f32 v71, v71, v76
    v_mul_f32 v72, v72, v76
    v_mul_f32 v73, v73, v76
    v_mul_f32 v74, v74, v76
    v_mul_f32 v75, v75, v76
    v_cvt_pk_bf16_f32 v128, v68, v69
    v_cvt_pk_bf16_f32 v129, v70, v71
    v_cvt_pk_bf16_f32 v130, v72, v73
    v_cvt_pk_bf16_f32 v131, v74, v75
Lt0done:
    buffer_store_dwordx4 v[128:131], v12, s[12:15], s72 offen offset:0 sc1
    buffer_store_dwordx4 v[144:147], v12, s[12:15], s72 offen offset:1024 sc1
    buffer_store_dwordx4 v[152:155], v12, s[12:15], s72 offen offset:2048 sc1
    buffer_store_dwordx4 v[162:165], v12, s[12:15], s72 offen offset:3072 sc1
    s_branch Lnoob
Lgate:
    v_mov_b64 v[168:169], 0
    v_dot2c_f32_bf16 v168, v144, v160
    v_dot2c_f32_bf16 v169, v152, v160
    v_dot2c_f32_bf16 v168, v145, v161
    v_dot2c_f32_bf16 v169, v153, v161
    v_dot2c_f32_bf16 v168, v146, v162
    v_dot2c_f32_bf16 v169, v154, v162
    v_dot2c_f32_bf16 v168, v147, v163
    v_dot2c_f32_bf16 v169, v155, v163
    v_dot2c_f32_bf16 v168, v148, v164
    v_dot2c_f32_bf16 v169, v156, v164
    v_dot2c_f32_bf16 v168, v149, v165
    v_dot2c_f32_bf16 v169, v157, v165
    v_dot2c_f32_bf16 v168, v150, v166
    v_dot2c_f32_bf16 v169, v158, v166
    v_dot2c_f32_bf16 v168, v151, v167
    v_dot2c_f32_bf16 v169, v159, v167
    s_nop 2
    v_add_f32_dpp v168, v168, v168 row_shr:1 row_mask:0xf bank_mask:0xf
    v_add_f32_dpp v169, v169, v169 row_shr:1 row_mask:0xf bank_mask:0xf
    s_nop 0
    v_add_f32_dpp v168, v168, v168 row_shr:2 row_mask:0xf bank_mask:0xf
    v_add_f32_dpp v169, v169, v169 row_shr:2 row_mask:0xf bank_mask:0xf
    s_nop 0
    v_add_f32_dpp v168, v168, v168 row_shr:4 row_mask:0xf bank_mask:0xf
    v_add_f32_dpp v169, v169, v169 row_shr:4 row_mask:0xf bank_mask:0xf
    s_nop 0
    v_add_f32_dpp v168, v168, v168 row_shr:8 row_mask:0xf bank_mask:0xf
    v_add_f32_dpp v169, v169, v169 row_shr:8 row_mask:0xf bank_mask:0xf
    s_nop 0
    v_add_f32_dpp v168, v168, v168 row_bcast:15 row_mask:0xa bank_mask:0xf
    v_add_f32_dpp v169, v169, v169 row_bcast:15 row_mask:0xa bank_mask:0xf
    s_nop 0
    v_add_f32_dpp v168, v168, v168 row_bcast:31 row_mask:0xc bank_mask:0xf
    v_add_f32_dpp v169, v169, v169 row_bcast:31 row_mask:0xc bank_mask:0xf
    s_nop 0
    v_mul_f32 v168, 0xbfb8aa3b, v168
    v_mul_f32 v169, 0xbfb8aa3b, v169
    v_exp_f32 v168, v168
    v_exp_f32 v169, v169
    s_lshl_b32 s47, s47, 3
    v_add_f32 v168, 1.0, v168
    v_add_f32 v169, 1.0, v169
    v_rcp_f32 v168, v168
    v_rcp_f32 v169, v169
    s_add_u32 s47, s47, 17825792
    s_mov_b32 s26, 0
    s_brev_b32 s27, 1
    s_mov_b64 exec, s[26:27]
    buffer_store_dwordx2 v[168:169], off, s[12:15], s47 sc1
    s_mov_b64 exec, -1
Lnoob:
    s_mov_b32 s4, s58
    s_mov_b32 s5, s59
    s_lshl_b32 s26, s43, 10
    v_add_u32 v176, s26, v12
    v_xor_b32 v177, 1024, v176
    s_lshl_b32 s26, s43, 11
    s_add_u32 s72, s72, s26
    s_add_u32 s72, s72, 4194304
    s_add_u32 s28, s98, 2
    s_waitcnt vmcnt(14)
    v_mfma_f32_32x32x16_bf16 v[56:71], v[212:215], v[180:183], 0
    v_mfma_f32_32x32x16_bf16 v[56:71], v[216:219], v[184:187], v[56:71]
    s_setprio 3
    s_nop 9
    s_branch Latt_b2
.p2align 6
Latt:
    v_mfma_f32_32x32x16_bf16 v[72:87], v[196:199], v[188:191], 0
    v_exp_f32 v56, v56
    v_exp_f32 v57, v57
    v_exp_f32 v58, v58
    v_exp_f32 v59, v59
    v_cvt_pk_bf16_f32 v88, v56, v57
    v_mfma_f32_32x32x16_bf16 v[72:87], v[200:203], v[192:195], v[72:87]
    buffer_load_dwordx4 v[196:199], v12, s[16:19], s30 offen offset:0
    v_exp_f32 v60, v60
    v_exp_f32 v61, v61
    v_cvt_pk_bf16_f32 v89, v58, v59
    v_exp_f32 v62, v62
    v_exp_f32 v63, v63
    v_cvt_pk_bf16_f32 v90, v60, v61
    v_mfma_f32_32x32x16_bf16 v[32:47], v[136:139], v[96:99], v[32:47]
    buffer_load_dwordx4 v[200:203], v12, s[16:19], s30 offen offset:1024
    v_exp_f32 v64, v64
    v_exp_f32 v65, v65
    v_cvt_pk_bf16_f32 v91, v62, v63
    v_exp_f32 v66, v66
    v_exp_f32 v67, v67
    v_mfma_f32_32x32x16_bf16 v[32:47], v[140:143], v[100:103], v[32:47]
    buffer_load_dwordx4 v[136:139], v12, s[16:19], s57 offen offset:2048
    v_cvt_pk_bf16_f32 v92, v64, v65
    v_exp_f32 v68, v68
    v_exp_f32 v69, v69
    v_cvt_pk_bf16_f32 v93, v66, v67
    v_exp_f32 v70, v70
    v_smfmac_f32_16x16x64_bf16 v[52:55], v[244:247], v[96:103], v248
    buffer_load_dwordx4 v[140:143], v12, s[16:19], s57 offen offset:3072
    s_waitcnt vmcnt(14)
    v_exp_f32 v71, v71
    v_cvt_pk_bf16_f32 v94, v68, v69
    v_cvt_pk_bf16_f32 v95, v70, v71
    v_mfma_f32_32x32x16_bf16 v[56:71], v[204:207], v[180:183], 0
    s_add_u32 s57, s30, 4096
    s_and_b32 s57, s57, 0x1ffff
    s_cmp_ge_u32 s32, s39
    s_cselect_b32 m0, 0x30000, s32
    v_exp_f32 v72, v72
    v_exp_f32 v73, v73
    v_exp_f32 v74, v74
    v_exp_f32 v75, v75
    v_cvt_pk_bf16_f32 v96, v72, v73
    v_mfma_f32_32x32x16_bf16 v[56:71], v[208:211], v[184:187], v[56:71]
    s_cselect_b32 s25, 0x40000000, s69
    s_add_u32 s32, s32, 4096
    v_exp_f32 v76, v76
    v_exp_f32 v77, v77
    v_cvt_pk_bf16_f32 v97, v74, v75
    v_exp_f32 v78, v78
    v_exp_f32 v79, v79
    v_cvt_pk_bf16_f32 v98, v76, v77
    v_mfma_f32_32x32x16_bf16 v[16:31], v[220:223], v[88:91], v[16:31]
    buffer_load_dwordx4 v252, s[64:67], s25 offen lds
    v_exp_f32 v80, v80
    v_exp_f32 v81, v81
    v_cvt_pk_bf16_f32 v99, v78, v79
    v_exp_f32 v82, v82
    v_exp_f32 v83, v83
    v_mfma_f32_32x32x16_bf16 v[16:31], v[224:227], v[92:95], v[16:31]
    buffer_load_dwordx4 v253, s[64:67], s25 offen offset:1024 lds
    v_cvt_pk_bf16_f32 v100, v80, v81
    v_exp_f32 v84, v84
    v_exp_f32 v85, v85
    v_cvt_pk_bf16_f32 v101, v82, v83
    v_exp_f32 v86, v86
    v_smfmac_f32_16x16x64_bf16 v[48:51], v[244:247], v[88:95], v248
    s_add_u32 s69, s69, 65536
    v_exp_f32 v87, v87
    v_cvt_pk_bf16_f32 v102, v84, v85
    v_cvt_pk_bf16_f32 v103, v86, v87
    v_mfma_f32_32x32x16_bf16 v[72:87], v[204:207], v[188:191], 0
    v_exp_f32 v56, v56
    v_exp_f32 v57, v57
    v_exp_f32 v58, v58
    v_exp_f32 v59, v59
    v_cvt_pk_bf16_f32 v88, v56, v57
    v_mfma_f32_32x32x16_bf16 v[72:87], v[208:211], v[192:195], v[72:87]
    buffer_load_dwordx4 v[204:207], v12, s[16:19], s57 offen offset:0
    v_exp_f32 v60, v60
    v_exp_f32 v61, v61
    v_cvt_pk_bf16_f32 v89, v58, v59
    v_exp_f32 v62, v62
    v_exp_f32 v63, v63
    v_cvt_pk_bf16_f32 v90, v60, v61
    v_mfma_f32_32x32x16_bf16 v[32:47], v[220:223], v[96:99], v[32:47]
    buffer_load_dwordx4 v[208:211], v12, s[16:19], s57 offen offset:1024
    v_exp_f32 v64, v64
    v_exp_f32 v65, v65
    v_cvt_pk_bf16_f32 v91, v62, v63
    v_exp_f32 v66, v66
    v_exp_f32 v67, v67
    v_mfma_f32_32x32x16_bf16 v[32:47], v[224:227], v[100:103], v[32:47]
    buffer_load_dwordx4 v[220:223], v12, s[16:19], s30 offen offset:2048
    v_cvt_pk_bf16_f32 v92, v64, v65
    v_exp_f32 v68, v68
    v_exp_f32 v69, v69
    v_cvt_pk_bf16_f32 v93, v66, v67
    v_exp_f32 v70, v70
    v_smfmac_f32_16x16x64_bf16 v[52:55], v[244:247], v[96:103], v248
    buffer_load_dwordx4 v[224:227], v12, s[16:19], s30 offen offset:3072
    s_waitcnt vmcnt(16)
    v_exp_f32 v71, v71
    v_cvt_pk_bf16_f32 v94, v68, v69
    v_cvt_pk_bf16_f32 v95, v70, v71
    v_mfma_f32_32x32x16_bf16 v[56:71], v[212:215], v[180:183], 0
    s_add_u32 s30, s57, 4096
    s_and_b32 s30, s30, 0x1ffff
    v_exp_f32 v72, v72
    v_exp_f32 v73, v73
    v_exp_f32 v74, v74
    v_exp_f32 v75, v75
    v_cvt_pk_bf16_f32 v96, v72, v73
    v_mfma_f32_32x32x16_bf16 v[56:71], v[216:219], v[184:187], v[56:71]
    v_exp_f32 v76, v76
    v_exp_f32 v77, v77
    v_cvt_pk_bf16_f32 v97, v74, v75
    v_exp_f32 v78, v78
    v_exp_f32 v79, v79
    v_cvt_pk_bf16_f32 v98, v76, v77
    v_mfma_f32_32x32x16_bf16 v[16:31], v[228:231], v[88:91], v[16:31]
    v_exp_f32 v80, v80
    v_exp_f32 v81, v81
    v_cvt_pk_bf16_f32 v99, v78, v79
    v_exp_f32 v82, v82
    v_exp_f32 v83, v83
    v_mfma_f32_32x32x16_bf16 v[16:31], v[232:235], v[92:95], v[16:31]
    v_cvt_pk_bf16_f32 v100, v80, v81
    v_exp_f32 v84, v84
    v_exp_f32 v85, v85
    v_cvt_pk_bf16_f32 v101, v82, v83
    v_exp_f32 v86, v86
    v_smfmac_f32_16x16x64_bf16 v[48:51], v[244:247], v[88:95], v248
    v_exp_f32 v87, v87
    v_cvt_pk_bf16_f32 v102, v84, v85
    v_cvt_pk_bf16_f32 v103, v86, v87
Latt_b2:
    v_mfma_f32_32x32x16_bf16 v[72:87], v[212:215], v[188:191], 0
    v_exp_f32 v56, v56
    v_exp_f32 v57, v57
    v_exp_f32 v58, v58
    v_exp_f32 v59, v59
    v_cvt_pk_bf16_f32 v88, v56, v57
    v_mfma_f32_32x32x16_bf16 v[72:87], v[216:219], v[192:195], v[72:87]
    buffer_load_dwordx4 v[212:215], v12, s[16:19], s30 offen offset:0
    v_exp_f32 v60, v60
    v_exp_f32 v61, v61
    v_cvt_pk_bf16_f32 v89, v58, v59
    v_exp_f32 v62, v62
    v_exp_f32 v63, v63
    v_cvt_pk_bf16_f32 v90, v60, v61
    v_mfma_f32_32x32x16_bf16 v[32:47], v[228:231], v[96:99], v[32:47]
    buffer_load_dwordx4 v[216:219], v12, s[16:19], s30 offen offset:1024
    v_exp_f32 v64, v64
    v_exp_f32 v65, v65
    v_cvt_pk_bf16_f32 v91, v62, v63
    v_exp_f32 v66, v66
    v_exp_f32 v67, v67
    v_mfma_f32_32x32x16_bf16 v[32:47], v[232:235], v[100:103], v[32:47]
    buffer_load_dwordx4 v[228:231], v12, s[16:19], s57 offen offset:2048
    v_cvt_pk_bf16_f32 v92, v64, v65
    v_exp_f32 v68, v68
    v_exp_f32 v69, v69
    v_cvt_pk_bf16_f32 v93, v66, v67
    v_exp_f32 v70, v70
    v_smfmac_f32_16x16x64_bf16 v[52:55], v[244:247], v[96:103], v248
    buffer_load_dwordx4 v[232:235], v12, s[16:19], s57 offen offset:3072
    s_waitcnt vmcnt(14)
    v_exp_f32 v71, v71
    v_cvt_pk_bf16_f32 v94, v68, v69
    v_cvt_pk_bf16_f32 v95, v70, v71
    v_mfma_f32_32x32x16_bf16 v[56:71], v[120:123], v[180:183], 0
    s_add_u32 s57, s30, 4096
    s_and_b32 s57, s57, 0x1ffff
    v_exp_f32 v72, v72
    v_exp_f32 v73, v73
    v_exp_f32 v74, v74
    v_exp_f32 v75, v75
    v_cvt_pk_bf16_f32 v96, v72, v73
    v_mfma_f32_32x32x16_bf16 v[56:71], v[124:127], v[184:187], v[56:71]
    v_exp_f32 v76, v76
    v_exp_f32 v77, v77
    v_cvt_pk_bf16_f32 v97, v74, v75
    v_exp_f32 v78, v78
    v_exp_f32 v79, v79
    v_cvt_pk_bf16_f32 v98, v76, v77
    v_mfma_f32_32x32x16_bf16 v[16:31], v[236:239], v[88:91], v[16:31]
    buffer_load_dwordx4 v254, s[64:67], s25 offen offset:2048 lds
    v_exp_f32 v80, v80
    v_exp_f32 v81, v81
    v_cvt_pk_bf16_f32 v99, v78, v79
    v_exp_f32 v82, v82
    v_exp_f32 v83, v83
    v_mfma_f32_32x32x16_bf16 v[16:31], v[240:243], v[92:95], v[16:31]
    buffer_load_dwordx4 v255, s[64:67], s25 offen offset:3072 lds
    v_cvt_pk_bf16_f32 v100, v80, v81
    v_exp_f32 v84, v84
    v_exp_f32 v85, v85
    v_cvt_pk_bf16_f32 v101, v82, v83
    v_exp_f32 v86, v86
    v_smfmac_f32_16x16x64_bf16 v[48:51], v[244:247], v[88:95], v248
    v_exp_f32 v87, v87
    v_cvt_pk_bf16_f32 v102, v84, v85
    v_cvt_pk_bf16_f32 v103, v86, v87
    v_mfma_f32_32x32x16_bf16 v[72:87], v[120:123], v[188:191], 0
    v_exp_f32 v56, v56
    v_exp_f32 v57, v57
    v_exp_f32 v58, v58
    v_exp_f32 v59, v59
    v_cvt_pk_bf16_f32 v88, v56, v57
    v_mfma_f32_32x32x16_bf16 v[72:87], v[124:127], v[192:195], v[72:87]
    buffer_load_dwordx4 v[120:123], v12, s[16:19], s57 offen offset:0
    v_exp_f32 v60, v60
    v_exp_f32 v61, v61
    v_cvt_pk_bf16_f32 v89, v58, v59
    v_exp_f32 v62, v62
    v_exp_f32 v63, v63
    v_cvt_pk_bf16_f32 v90, v60, v61
    v_mfma_f32_32x32x16_bf16 v[32:47], v[236:239], v[96:99], v[32:47]
    buffer_load_dwordx4 v[124:127], v12, s[16:19], s57 offen offset:1024
    v_exp_f32 v64, v64
    v_exp_f32 v65, v65
    v_cvt_pk_bf16_f32 v91, v62, v63
    v_exp_f32 v66, v66
    v_exp_f32 v67, v67
    v_mfma_f32_32x32x16_bf16 v[32:47], v[240:243], v[100:103], v[32:47]
    buffer_load_dwordx4 v[236:239], v12, s[16:19], s30 offen offset:2048
    v_cvt_pk_bf16_f32 v92, v64, v65
    v_exp_f32 v68, v68
    v_exp_f32 v69, v69
    v_cvt_pk_bf16_f32 v93, v66, v67
    v_exp_f32 v70, v70
    v_smfmac_f32_16x16x64_bf16 v[52:55], v[244:247], v[96:103], v248
    buffer_load_dwordx4 v[240:243], v12, s[16:19], s30 offen offset:3072
    s_waitcnt vmcnt(16)
    v_exp_f32 v71, v71
    v_cvt_pk_bf16_f32 v94, v68, v69
    v_cvt_pk_bf16_f32 v95, v70, v71
    v_mfma_f32_32x32x16_bf16 v[56:71], v[196:199], v[180:183], 0
    s_add_u32 s30, s57, 4096
    s_and_b32 s30, s30, 0x1ffff
    v_exp_f32 v72, v72
    v_exp_f32 v73, v73
    v_exp_f32 v74, v74
    v_exp_f32 v75, v75
    v_cvt_pk_bf16_f32 v96, v72, v73
    v_mfma_f32_32x32x16_bf16 v[56:71], v[200:203], v[184:187], v[56:71]
    v_exp_f32 v76, v76
    v_exp_f32 v77, v77
    v_cvt_pk_bf16_f32 v97, v74, v75
    v_exp_f32 v78, v78
    v_exp_f32 v79, v79
    v_cvt_pk_bf16_f32 v98, v76, v77
    v_mfma_f32_32x32x16_bf16 v[16:31], v[136:139], v[88:91], v[16:31]
    v_exp_f32 v80, v80
    v_exp_f32 v81, v81
    v_cvt_pk_bf16_f32 v99, v78, v79
    v_exp_f32 v82, v82
    v_exp_f32 v83, v83
    v_mfma_f32_32x32x16_bf16 v[16:31], v[140:143], v[92:95], v[16:31]
    v_cvt_pk_bf16_f32 v100, v80, v81
    v_exp_f32 v84, v84
    v_exp_f32 v85, v85
    v_cvt_pk_bf16_f32 v101, v82, v83
    v_exp_f32 v86, v86
    v_smfmac_f32_16x16x64_bf16 v[48:51], v[244:247], v[88:95], v248
    v_exp_f32 v87, v87
    v_cvt_pk_bf16_f32 v102, v84, v85
    v_cvt_pk_bf16_f32 v103, v86, v87
    s_cmp_eq_u32 s37, s51
    s_cbranch_scc1 Levent
Levent_ret:
    s_sub_u32 s37, s37, 1
    s_cmp_lg_u32 s37, 0
    s_cbranch_scc1 Latt
    v_mfma_f32_32x32x16_bf16 v[72:87], v[196:199], v[188:191], 0
    buffer_load_dword v9, v8, s[12:15], s101 offen sc1
    v_exp_f32 v56, v56
    v_exp_f32 v57, v57
    v_exp_f32 v58, v58
    v_exp_f32 v59, v59
    v_cvt_pk_bf16_f32 v88, v56, v57
    v_mfma_f32_32x32x16_bf16 v[72:87], v[200:203], v[192:195], v[72:87]
    v_exp_f32 v60, v60
    v_exp_f32 v61, v61
    v_cvt_pk_bf16_f32 v89, v58, v59
    v_exp_f32 v62, v62
    v_exp_f32 v63, v63
    v_cvt_pk_bf16_f32 v90, v60, v61
    v_mfma_f32_32x32x16_bf16 v[32:47], v[136:139], v[96:99], v[32:47]
    v_exp_f32 v64, v64
    v_exp_f32 v65, v65
    v_cvt_pk_bf16_f32 v91, v62, v63
    v_exp_f32 v66, v66
    v_exp_f32 v67, v67
    v_mfma_f32_32x32x16_bf16 v[32:47], v[140:143], v[100:103], v[32:47]
    buffer_load_dwordx4 v[136:139], v12, s[16:19], s57 offen offset:2048
    v_cvt_pk_bf16_f32 v92, v64, v65
    v_exp_f32 v68, v68
    v_exp_f32 v69, v69
    v_cvt_pk_bf16_f32 v93, v66, v67
    v_exp_f32 v70, v70
    v_smfmac_f32_16x16x64_bf16 v[52:55], v[244:247], v[96:103], v248
    buffer_load_dwordx4 v[140:143], v12, s[16:19], s57 offen offset:3072
    s_waitcnt vmcnt(13)
    v_exp_f32 v71, v71
    v_cvt_pk_bf16_f32 v94, v68, v69
    v_cvt_pk_bf16_f32 v95, v70, v71
    v_mfma_f32_32x32x16_bf16 v[56:71], v[204:207], v[180:183], 0
    v_exp_f32 v72, v72
    v_exp_f32 v73, v73
    v_exp_f32 v74, v74
    v_exp_f32 v75, v75
    v_cvt_pk_bf16_f32 v96, v72, v73
    v_mfma_f32_32x32x16_bf16 v[56:71], v[208:211], v[184:187], v[56:71]
    v_exp_f32 v76, v76
    v_exp_f32 v77, v77
    v_cvt_pk_bf16_f32 v97, v74, v75
    v_exp_f32 v78, v78
    v_exp_f32 v79, v79
    v_cvt_pk_bf16_f32 v98, v76, v77
    v_mfma_f32_32x32x16_bf16 v[16:31], v[220:223], v[88:91], v[16:31]
    v_exp_f32 v80, v80
    v_exp_f32 v81, v81
    v_cvt_pk_bf16_f32 v99, v78, v79
    v_exp_f32 v82, v82
    v_exp_f32 v83, v83
    v_mfma_f32_32x32x16_bf16 v[16:31], v[224:227], v[92:95], v[16:31]
    v_cvt_pk_bf16_f32 v100, v80, v81
    v_exp_f32 v84, v84
    v_exp_f32 v85, v85
    v_cvt_pk_bf16_f32 v101, v82, v83
    v_exp_f32 v86, v86
    v_smfmac_f32_16x16x64_bf16 v[48:51], v[244:247], v[88:95], v248
    v_exp_f32 v87, v87
    v_cvt_pk_bf16_f32 v102, v84, v85
    v_cvt_pk_bf16_f32 v103, v86, v87
    v_mfma_f32_32x32x16_bf16 v[72:87], v[204:207], v[188:191], 0
    v_exp_f32 v56, v56
    v_exp_f32 v57, v57
    v_exp_f32 v58, v58
    v_exp_f32 v59, v59
    v_cvt_pk_bf16_f32 v88, v56, v57
    v_mfma_f32_32x32x16_bf16 v[72:87], v[208:211], v[192:195], v[72:87]
    v_exp_f32 v60, v60
    v_exp_f32 v61, v61
    v_cvt_pk_bf16_f32 v89, v58, v59
    v_exp_f32 v62, v62
    v_exp_f32 v63, v63
    v_cvt_pk_bf16_f32 v90, v60, v61
    v_mfma_f32_32x32x16_bf16 v[32:47], v[220:223], v[96:99], v[32:47]
    v_exp_f32 v64, v64
    v_exp_f32 v65, v65
    v_cvt_pk_bf16_f32 v91, v62, v63
    v_exp_f32 v66, v66
    v_exp_f32 v67, v67
    v_mfma_f32_32x32x16_bf16 v[32:47], v[224:227], v[100:103], v[32:47]
    v_cvt_pk_bf16_f32 v92, v64, v65
    v_exp_f32 v68, v68
    v_exp_f32 v69, v69
    v_cvt_pk_bf16_f32 v93, v66, v67
    v_exp_f32 v70, v70
    v_smfmac_f32_16x16x64_bf16 v[52:55], v[244:247], v[96:103], v248
    s_waitcnt vmcnt(2)
    v_exp_f32 v71, v71
    v_cvt_pk_bf16_f32 v94, v68, v69
    v_cvt_pk_bf16_f32 v95, v70, v71
    v_mfma_f32_32x32x16_bf16 v[56:71], v[212:215], v[180:183], 0
    v_subrev_u32 v9, s28, v9
    v_cmp_ge_u32 vcc, 1, v9
    v_exp_f32 v72, v72
    v_exp_f32 v73, v73
    v_exp_f32 v74, v74
    v_exp_f32 v75, v75
    v_cvt_pk_bf16_f32 v96, v72, v73
    v_mfma_f32_32x32x16_bf16 v[56:71], v[216:219], v[184:187], v[56:71]
    s_cmp_eq_u64 vcc, -1
    s_cbranch_scc0 Lpoll2_slow
Lpoll2_ret:
    v_exp_f32 v76, v76
    v_exp_f32 v77, v77
    v_cvt_pk_bf16_f32 v97, v74, v75
    v_exp_f32 v78, v78
    v_exp_f32 v79, v79
    v_cvt_pk_bf16_f32 v98, v76, v77
    v_mfma_f32_32x32x16_bf16 v[16:31], v[228:231], v[88:91], v[16:31]
    buffer_load_dword v13, v15, s[8:11], s46 offen sc1
    v_exp_f32 v80, v80
    v_exp_f32 v81, v81
    v_cvt_pk_bf16_f32 v99, v78, v79
    v_exp_f32 v82, v82
    v_exp_f32 v83, v83
    v_mfma_f32_32x32x16_bf16 v[16:31], v[232:235], v[92:95], v[16:31]
    buffer_load_dwordx4 v[128:131], v176, s[12:15], s50 offen sc1
    v_cvt_pk_bf16_f32 v100, v80, v81
    v_exp_f32 v84, v84
    v_exp_f32 v85, v85
    v_cvt_pk_bf16_f32 v101, v82, v83
    v_exp_f32 v86, v86
    v_smfmac_f32_16x16x64_bf16 v[48:51], v[244:247], v[88:95], v248
    buffer_load_dwordx4 v[132:135], v177, s[12:15], s50 offen sc1
    s_add_u32 s50, s50, 131072
    v_exp_f32 v87, v87
    v_cvt_pk_bf16_f32 v102, v84, v85
    v_cvt_pk_bf16_f32 v103, v86, v87
    s_setprio 0
    v_mfma_f32_32x32x16_bf16 v[72:87], v[212:215], v[188:191], 0
    v_exp_f32 v56, v56
    v_exp_f32 v57, v57
    v_exp_f32 v58, v58
    v_exp_f32 v59, v59
    v_cvt_pk_bf16_f32 v88, v56, v57
    v_mfma_f32_32x32x16_bf16 v[72:87], v[216:219], v[192:195], v[72:87]
    buffer_load_dwordx4 v[144:147], v176, s[12:15], s50 offen sc1
    v_exp_f32 v60, v60
    v_exp_f32 v61, v61
    v_cvt_pk_bf16_f32 v89, v58, v59
    v_exp_f32 v62, v62
    v_exp_f32 v63, v63
    v_cvt_pk_bf16_f32 v90, v60, v61
    v_mfma_f32_32x32x16_bf16 v[32:47], v[228:231], v[96:99], v[32:47]
    buffer_load_dwordx4 v[148:151], v177, s[12:15], s50 offen sc1
    s_add_u32 s50, s50, 131072
    v_exp_f32 v64, v64
    v_exp_f32 v65, v65
    v_cvt_pk_bf16_f32 v91, v62, v63
    v_exp_f32 v66, v66
    v_exp_f32 v67, v67
    v_mfma_f32_32x32x16_bf16 v[32:47], v[232:235], v[100:103], v[32:47]
    buffer_load_dwordx4 v[152:155], v176, s[12:15], s50 offen sc1
    v_cvt_pk_bf16_f32 v92, v64, v65
    v_exp_f32 v68, v68
    v_exp_f32 v69, v69
    v_cvt_pk_bf16_f32 v93, v66, v67
    v_exp_f32 v70, v70
    v_smfmac_f32_16x16x64_bf16 v[52:55], v[244:247], v[96:103], v248
    buffer_load_dwordx4 v[156:159], v177, s[12:15], s50 offen sc1
    s_add_u32 s50, s50, 131072
    s_waitcnt vmcnt(10)
    v_exp_f32 v71, v71
    v_cvt_pk_bf16_f32 v94, v68, v69
    v_cvt_pk_bf16_f32 v95, v70, v71
    v_mfma_f32_32x32x16_bf16 v[56:71], v[120:123], v[180:183], 0
    v_exp_f32 v72, v72
    v_exp_f32 v73, v73
    v_exp_f32 v74, v74
    v_exp_f32 v75, v75
    v_cvt_pk_bf16_f32 v96, v72, v73
    v_mfma_f32_32x32x16_bf16 v[56:71], v[124:127], v[184:187], v[56:71]
    buffer_load_dwordx4 v[160:163], v176, s[12:15], s50 offen sc1
    v_exp_f32 v76, v76
    v_exp_f32 v77, v77
    v_cvt_pk_bf16_f32 v97, v74, v75
    v_exp_f32 v78, v78
    v_exp_f32 v79, v79
    v_cvt_pk_bf16_f32 v98, v76, v77
    v_mfma_f32_32x32x16_bf16 v[16:31], v[236:239], v[88:91], v[16:31]
    buffer_load_dwordx4 v[164:167], v177, s[12:15], s50 offen sc1
    s_add_u32 s50, s50, 131072
    v_exp_f32 v80, v80
    v_exp_f32 v81, v81
    v_cvt_pk_bf16_f32 v99, v78, v79
    v_exp_f32 v82, v82
    v_exp_f32 v83, v83
    v_mfma_f32_32x32x16_bf16 v[16:31], v[240:243], v[92:95], v[16:31]
    buffer_load_dwordx4 v[168:171], v176, s[12:15], s50 offen sc1
    v_cvt_pk_bf16_f32 v100, v80, v81
    v_exp_f32 v84, v84
    v_exp_f32 v85, v85
    v_cvt_pk_bf16_f32 v101, v82, v83
    v_exp_f32 v86, v86
    v_smfmac_f32_16x16x64_bf16 v[48:51], v[244:247], v[88:95], v248
    buffer_load_dwordx4 v[172:175], v177, s[12:15], s50 offen sc1
    s_add_u32 s50, s50, 131072
    v_exp_f32 v87, v87
    v_cvt_pk_bf16_f32 v102, v84, v85
    v_cvt_pk_bf16_f32 v103, v86, v87
    v_mfma_f32_32x32x16_bf16 v[72:87], v[120:123], v[188:191], 0
    v_exp_f32 v56, v56
    v_exp_f32 v57, v57
    v_exp_f32 v58, v58
    v_exp_f32 v59, v59
    v_cvt_pk_bf16_f32 v88, v56, v57
    v_mfma_f32_32x32x16_bf16 v[72:87], v[124:127], v[192:195], v[72:87]
    buffer_load_dwordx4 v[196:199], v176, s[12:15], s50 offen sc1
    v_exp_f32 v60, v60
    v_exp_f32 v61, v61
    v_cvt_pk_bf16_f32 v89, v58, v59
    v_exp_f32 v62, v62
    v_exp_f32 v63, v63
    v_cvt_pk_bf16_f32 v90, v60, v61
    v_mfma_f32_32x32x16_bf16 v[32:47], v[236:239], v[96:99], v[32:47]
    buffer_load_dwordx4 v[200:203], v177, s[12:15], s50 offen sc1
    s_add_u32 s50, s50, 131072
    v_exp_f32 v64, v64
    v_exp_f32 v65, v65
    v_cvt_pk_bf16_f32 v91, v62, v63
    v_exp_f32 v66, v66
    v_exp_f32 v67, v67
    v_mfma_f32_32x32x16_bf16 v[32:47], v[240:243], v[100:103], v[32:47]
    buffer_load_dwordx4 v[204:207], v176, s[12:15], s50 offen sc1
    v_cvt_pk_bf16_f32 v92, v64, v65
    v_exp_f32 v68, v68
    v_exp_f32 v69, v69
    v_cvt_pk_bf16_f32 v93, v66, v67
    v_exp_f32 v70, v70
    v_smfmac_f32_16x16x64_bf16 v[52:55], v[244:247], v[96:103], v248
    buffer_load_dwordx4 v[208:211], v177, s[12:15], s50 offen sc1
    s_add_u32 s50, s50, 131072
    s_waitcnt vmcnt(15)
    v_exp_f32 v71, v71
    v_cvt_pk_bf16_f32 v94, v68, v69
    v_cvt_pk_bf16_f32 v95, v70, v71
    v_exp_f32 v72, v72
    v_exp_f32 v73, v73
    v_exp_f32 v74, v74
    v_exp_f32 v75, v75
    v_cvt_pk_bf16_f32 v96, v72, v73
    buffer_load_dwordx4 v[220:223], v176, s[12:15], s50 offen sc1
    v_exp_f32 v76, v76
    v_exp_f32 v77, v77
    v_cvt_pk_bf16_f32 v97, v74, v75
    v_exp_f32 v78, v78
    v_exp_f32 v79, v79
    v_cvt_pk_bf16_f32 v98, v76, v77
    v_mfma_f32_32x32x16_bf16 v[16:31], v[136:139], v[88:91], v[16:31]
    buffer_load_dwordx4 v[224:227], v177, s[12:15], s50 offen sc1
    s_add_u32 s50, s50, 131072
    v_exp_f32 v80, v80
    v_exp_f32 v81, v81
    v_cvt_pk_bf16_f32 v99, v78, v79
    v_exp_f32 v82, v82
    v_exp_f32 v83, v83
    v_mfma_f32_32x32x16_bf16 v[16:31], v[140:143], v[92:95], v[16:31]
    buffer_load_dwordx4 v[212:215], v176, s[12:15], s50 offen sc1
    v_cvt_pk_bf16_f32 v100, v80, v81
    v_exp_f32 v84, v84
    v_exp_f32 v85, v85
    v_cvt_pk_bf16_f32 v101, v82, v83
    v_exp_f32 v86, v86
    v_smfmac_f32_16x16x64_bf16 v[48:51], v[244:247], v[88:95], v248
    buffer_load_dwordx4 v[216:219], v177, s[12:15], s50 offen sc1
    s_add_u32 s50, s50, 131072
    v_exp_f32 v87, v87
    v_cvt_pk_bf16_f32 v102, v84, v85
    v_cvt_pk_bf16_f32 v103, v86, v87
    s_nop 1
    v_mfma_f32_32x32x16_bf16 v[32:47], v[136:139], v[96:99], v[32:47]
    v_mfma_f32_32x32x16_bf16 v[32:47], v[140:143], v[100:103], v[32:47]
    v_smfmac_f32_16x16x64_bf16 v[52:55], v[244:247], v[96:103], v248
Lcomb:
    v_add_f32 v48, v48, v49
    s_nop 9
    v_add_f32 v52, v52, v53
    ds_write_b128 v4, v[32:35] offset:0
    ds_write_b128 v4, v[36:39] offset:1024
    ds_write_b128 v4, v[40:43] offset:2048
    ds_write_b128 v4, v[44:47] offset:3072
    ds_write_b32 v6, v52 offset:4096
    s_waitcnt lgkmcnt(0)
    s_barrier
    ds_read_b32 v72, v7 offset:4096
    ds_read_b128 v[56:59], v5 offset:0
    ds_read_b128 v[60:63], v5 offset:1024
    ds_read_b128 v[64:67], v5 offset:2048
    ds_read_b128 v[68:71], v5 offset:3072
    ds_read_b64_tr_b16 v[112:113], v104 offset:4096
    ds_read_b64_tr_b16 v[114:115], v104 offset:6144
    ds_read_b64_tr_b16 v[116:117], v105 offset:4096
    ds_read_b64_tr_b16 v[118:119], v105 offset:6144
    ds_read_b64_tr_b16 v[120:121], v106 offset:4096
    ds_read_b64_tr_b16 v[122:123], v106 offset:6144
    ds_read_b64_tr_b16 v[124:125], v107 offset:4096
    ds_read_b64_tr_b16 v[126:127], v107 offset:6144
    s_waitcnt lgkmcnt(12)
    v_add_f32 v48, v48, v72
    v_rcp_f32 v49, v48
    v_mul_f32 v11, 0, v48
    s_waitcnt lgkmcnt(11)
    v_add_f32 v16, v16, v56
    v_add_f32 v17, v17, v57
    v_add_f32 v18, v18, v58
    v_add_f32 v19, v19, v59
    s_waitcnt lgkmcnt(10)
    v_add_f32 v20, v20, v60
    v_add_f32 v21, v21, v61
    v_add_f32 v22, v22, v62
    v_add_f32 v23, v23, v63
    s_waitcnt lgkmcnt(9)
    v_add_f32 v24, v24, v64
    v_add_f32 v25, v25, v65
    v_add_f32 v26, v26, v66
    v_add_f32 v27, v27, v67
    s_waitcnt lgkmcnt(8)
    v_add_f32 v28, v28, v68
    v_add_f32 v29, v29, v69
    v_add_f32 v30, v30, v70
    v_add_f32 v31, v31, v71
    v_mul_f32 v32, v16, v49
    v_mul_f32 v33, v17, v49
    v_mul_f32 v34, v18, v49
    v_mul_f32 v35, v19, v49
    v_mul_f32 v36, v20, v49
    v_mul_f32 v37, v21, v49
    v_mul_f32 v38, v22, v49
    v_mul_f32 v39, v23, v49
    v_mul_f32 v40, v24, v49
    v_mul_f32 v41, v25, v49
    v_mul_f32 v42, v26, v49
    v_mul_f32 v43, v27, v49
    v_mul_f32 v44, v28, v49
    v_mul_f32 v45, v29, v49
    v_mul_f32 v46, v30, v49
    v_mul_f32 v47, v31, v49
    v_cvt_pk_bf16_f32 v72, v32, v33
    v_cvt_pk_bf16_f32 v73, v34, v35
    v_cvt_pk_bf16_f32 v74, v36, v37
    v_cvt_pk_bf16_f32 v75, v38, v39
    v_cvt_pk_bf16_f32 v76, v40, v41
    v_cvt_pk_bf16_f32 v77, v42, v43
    v_cvt_pk_bf16_f32 v78, v44, v45
    v_cvt_pk_bf16_f32 v79, v46, v47
    buffer_store_dwordx4 v[72:75], v250, s[12:15], s72 offen sc1
    buffer_store_dwordx4 v[76:79], v250, s[12:15], s72 offen offset:512 sc1
    ds_read_b64_tr_b16 v[80:81], v104 offset:0
    ds_read_b64_tr_b16 v[82:83], v104 offset:2048
    ds_read_b64_tr_b16 v[84:85], v105 offset:0
    ds_read_b64_tr_b16 v[86:87], v105 offset:2048
    ds_read_b64_tr_b16 v[88:89], v106 offset:0
    ds_read_b64_tr_b16 v[90:91], v106 offset:2048
    ds_read_b64_tr_b16 v[92:93], v107 offset:0
    ds_read_b64_tr_b16 v[94:95], v107 offset:2048
    v_fmac_f32 v11, 0, v16
    v_fmac_f32 v11, 0, v17
    v_fmac_f32 v11, 0, v18
    v_fmac_f32 v11, 0, v19
    v_fmac_f32 v11, 0, v20
    v_fmac_f32 v11, 0, v21
    v_fmac_f32 v11, 0, v22
    v_fmac_f32 v11, 0, v23
    v_fmac_f32 v11, 0, v24
    v_fmac_f32 v11, 0, v25
    v_fmac_f32 v11, 0, v26
    v_fmac_f32 v11, 0, v27
    v_fmac_f32 v11, 0, v28
    v_fmac_f32 v11, 0, v29
    v_fmac_f32 v11, 0, v30
    v_fmac_f32 v11, 0, v31
    v_min_f32 v48, v48, v49
    v_cmp_neq_f32 s[26:27], 0, v11
    v_cmp_nle_f32 vcc, 0x21800000, v48
    s_nop 0
    s_or_b64 vcc, vcc, s[26:27]
    s_cbranch_vccnz Lbad
Lbad_ret:
    s_waitcnt vmcnt(18) lgkmcnt(0)
    v_mfma_f32_16x16x32_bf16 v[16:19], v[80:83], v[128:131], 0
    ds_read_b64_tr_b16 v[228:229], v104 offset:8192
    v_mfma_f32_16x16x32_bf16 v[20:23], v[84:87], v[128:131], 0
    ds_read_b64_tr_b16 v[230:231], v104 offset:10240
    v_mfma_f32_16x16x32_bf16 v[24:27], v[88:91], v[128:131], 0
    ds_read_b64_tr_b16 v[232:233], v105 offset:8192
    v_mfma_f32_16x16x32_bf16 v[28:31], v[92:95], v[128:131], 0
    ds_read_b64_tr_b16 v[234:235], v105 offset:10240
    v_mfma_f32_16x16x32_bf16 v[32:35], v[80:83], v[132:135], 0
    ds_read_b64_tr_b16 v[236:237], v106 offset:8192
    v_mfma_f32_16x16x32_bf16 v[36:39], v[84:87], v[132:135], 0
    ds_read_b64_tr_b16 v[238:239], v106 offset:10240
    v_mfma_f32_16x16x32_bf16 v[40:43], v[88:91], v[132:135], 0
    ds_read_b64_tr_b16 v[240:241], v107 offset:8192
    v_mfma_f32_16x16x32_bf16 v[44:47], v[92:95], v[132:135], 0
    ds_read_b64_tr_b16 v[242:243], v107 offset:10240
    buffer_load_dwordx4 v[136:139], v176, s[12:15], s50 offen sc1
    buffer_load_dwordx4 v[140:143], v177, s[12:15], s50 offen sc1
    s_add_u32 s50, s50, 131072
    s_waitcnt vmcnt(18) lgkmcnt(8)
    v_mfma_f32_16x16x32_bf16 v[16:19], v[112:115], v[144:147], v[16:19]
    ds_read_b64_tr_b16 v[80:81], v104 offset:12288
    v_mfma_f32_16x16x32_bf16 v[20:23], v[116:119], v[144:147], v[20:23]
    ds_read_b64_tr_b16 v[82:83], v104 offset:14336
    v_mfma_f32_16x16x32_bf16 v[24:27], v[120:123], v[144:147], v[24:27]
    ds_read_b64_tr_b16 v[84:85], v105 offset:12288
    v_mfma_f32_16x16x32_bf16 v[28:31], v[124:127], v[144:147], v[28:31]
    ds_read_b64_tr_b16 v[86:87], v105 offset:14336
    v_mfma_f32_16x16x32_bf16 v[32:35], v[112:115], v[148:151], v[32:35]
    ds_read_b64_tr_b16 v[88:89], v106 offset:12288
    v_mfma_f32_16x16x32_bf16 v[36:39], v[116:119], v[148:151], v[36:39]
    ds_read_b64_tr_b16 v[90:91], v106 offset:14336
    v_mfma_f32_16x16x32_bf16 v[40:43], v[120:123], v[148:151], v[40:43]
    ds_read_b64_tr_b16 v[92:93], v107 offset:12288
    v_mfma_f32_16x16x32_bf16 v[44:47], v[124:127], v[148:151], v[44:47]
    ds_read_b64_tr_b16 v[94:95], v107 offset:14336
    buffer_load_dwordx4 v[96:99], v176, s[12:15], s50 offen sc1
    buffer_load_dwordx4 v[100:103], v177, s[12:15], s50 offen sc1
    s_add_u32 s50, s50, 131072
    s_waitcnt vmcnt(18) lgkmcnt(8)
    v_mfma_f32_16x16x32_bf16 v[16:19], v[228:231], v[152:155], v[16:19]
    ds_read_b64_tr_b16 v[112:113], v104 offset:16384
    v_mfma_f32_16x16x32_bf16 v[20:23], v[232:235], v[152:155], v[20:23]
    ds_read_b64_tr_b16 v[114:115], v104 offset:18432
    v_mfma_f32_16x16x32_bf16 v[24:27], v[236:239], v[152:155], v[24:27]
    ds_read_b64_tr_b16 v[116:117], v105 offset:16384
    v_mfma_f32_16x16x32_bf16 v[28:31], v[240:243], v[152:155], v[28:31]
    ds_read_b64_tr_b16 v[118:119], v105 offset:18432
    v_mfma_f32_16x16x32_bf16 v[32:35], v[228:231], v[156:159], v[32:35]
    ds_read_b64_tr_b16 v[120:121], v106 offset:16384
    v_mfma_f32_16x16x32_bf16 v[36:39], v[232:235], v[156:159], v[36:39]
    ds_read_b64_tr_b16 v[122:123], v106 offset:18432
    v_mfma_f32_16x16x32_bf16 v[40:43], v[236:239], v[156:159], v[40:43]
    ds_read_b64_tr_b16 v[124:125], v107 offset:16384
    v_mfma_f32_16x16x32_bf16 v[44:47], v[240:243], v[156:159], v[44:47]
    ds_read_b64_tr_b16 v[126:127], v107 offset:18432
    buffer_load_dwordx4 v[56:59], v176, s[12:15], s50 offen sc1
    buffer_load_dwordx4 v[60:63], v177, s[12:15], s50 offen sc1
    s_add_u32 s50, s50, 131072
    s_waitcnt vmcnt(18) lgkmcnt(8)
    v_mfma_f32_16x16x32_bf16 v[16:19], v[80:83], v[160:163], v[16:19]
    ds_read_b64_tr_b16 v[228:229], v104 offset:20480
    v_mfma_f32_16x16x32_bf16 v[20:23], v[84:87], v[160:163], v[20:23]
    ds_read_b64_tr_b16 v[230:231], v104 offset:22528
    v_mfma_f32_16x16x32_bf16 v[24:27], v[88:91], v[160:163], v[24:27]
    ds_read_b64_tr_b16 v[232:233], v105 offset:20480
    v_mfma_f32_16x16x32_bf16 v[28:31], v[92:95], v[160:163], v[28:31]
    ds_read_b64_tr_b16 v[234:235], v105 offset:22528
    v_mfma_f32_16x16x32_bf16 v[32:35], v[80:83], v[164:167], v[32:35]
    ds_read_b64_tr_b16 v[236:237], v106 offset:20480
    v_mfma_f32_16x16x32_bf16 v[36:39], v[84:87], v[164:167], v[36:39]
    ds_read_b64_tr_b16 v[238:239], v106 offset:22528
    v_mfma_f32_16x16x32_bf16 v[40:43], v[88:91], v[164:167], v[40:43]
    ds_read_b64_tr_b16 v[240:241], v107 offset:20480
    v_mfma_f32_16x16x32_bf16 v[44:47], v[92:95], v[164:167], v[44:47]
    ds_read_b64_tr_b16 v[242:243], v107 offset:22528
    buffer_load_dwordx4 v[64:67], v176, s[12:15], s50 offen sc1
    buffer_load_dwordx4 v[68:71], v177, s[12:15], s50 offen sc1
    s_add_u32 s50, s50, 131072
    s_waitcnt vmcnt(8)
    s_barrier
    ds_read_b32 v9, v10 offset:4
    s_and_b32 s27, s20, 3
    s_lshl_b32 s32, s43, 4
    s_add_u32 s32, s32, s27
    s_lshl_b32 s30, s32, 16
    s_add_u32 s30, s30, s71
    s_lshl_b32 s32, s32, 12
    s_lshl_b32 s27, s20, 12
    s_add_u32 s27, s27, 131072
    s_add_u32 s69, s71, 2031616
    s_waitcnt lgkmcnt(0)
    v_readfirstlane_b32 s26, v9
    s_cmp_eq_u32 s20, 7
    s_cselect_b32 m0, s39, s27
    s_cselect_b32 s69, s69, s30
    s_cmp_gt_u32 s26, s74
    s_cbranch_scc1 Lslow
    s_cmp_eq_u32 s20, 7
    s_cselect_b32 s64, s54, s48
    s_cselect_b32 s65, s55, s49
    s_cmp_lg_u32 s20, 0
    s_cbranch_scc1 Lp3_nf
    s_add_u32 s36, s98, 3
    v_mov_b32 v9, s36
    s_mov_b64 exec, 1
    buffer_store_dword v9, off, s[12:15], s100 sc1
    s_mov_b64 exec, -1
Lp3_nf:
    s_waitcnt vmcnt(18) lgkmcnt(8)
    v_mfma_f32_16x16x32_bf16 v[16:19], v[112:115], v[168:171], v[16:19]
    ds_read_b64_tr_b16 v[80:81], v104 offset:24576
    v_mfma_f32_16x16x32_bf16 v[20:23], v[116:119], v[168:171], v[20:23]
    ds_read_b64_tr_b16 v[82:83], v104 offset:26624
    buffer_load_dwordx4 v252, s[64:67], s69 offen offset:0 lds
    v_mfma_f32_16x16x32_bf16 v[24:27], v[120:123], v[168:171], v[24:27]
    ds_read_b64_tr_b16 v[84:85], v105 offset:24576
    v_mfma_f32_16x16x32_bf16 v[28:31], v[124:127], v[168:171], v[28:31]
    ds_read_b64_tr_b16 v[86:87], v105 offset:26624
    v_mfma_f32_16x16x32_bf16 v[32:35], v[112:115], v[172:175], v[32:35]
    ds_read_b64_tr_b16 v[88:89], v106 offset:24576
    v_mfma_f32_16x16x32_bf16 v[36:39], v[116:119], v[172:175], v[36:39]
    ds_read_b64_tr_b16 v[90:91], v106 offset:26624
    buffer_load_dwordx4 v253, s[64:67], s69 offen offset:1024 lds
    v_mfma_f32_16x16x32_bf16 v[40:43], v[120:123], v[172:175], v[40:43]
    ds_read_b64_tr_b16 v[92:93], v107 offset:24576
    v_mfma_f32_16x16x32_bf16 v[44:47], v[124:127], v[172:175], v[44:47]
    ds_read_b64_tr_b16 v[94:95], v107 offset:26624
    buffer_load_dwordx4 v[72:75], v176, s[12:15], s50 offen sc1
    buffer_load_dwordx4 v[76:79], v177, s[12:15], s50 offen sc1
    s_add_u32 s50, s50, 131072
    s_waitcnt vmcnt(20) lgkmcnt(8)
    v_mfma_f32_16x16x32_bf16 v[16:19], v[228:231], v[196:199], v[16:19]
    ds_read_b64_tr_b16 v[112:113], v104 offset:28672
    v_mfma_f32_16x16x32_bf16 v[20:23], v[232:235], v[196:199], v[20:23]
    ds_read_b64_tr_b16 v[114:115], v104 offset:30720
    buffer_load_dwordx4 v254, s[64:67], s69 offen offset:2048 lds
    v_mfma_f32_16x16x32_bf16 v[24:27], v[236:239], v[196:199], v[24:27]
    ds_read_b64_tr_b16 v[116:117], v105 offset:28672
    v_mfma_f32_16x16x32_bf16 v[28:31], v[240:243], v[196:199], v[28:31]
    ds_read_b64_tr_b16 v[118:119], v105 offset:30720
    v_mfma_f32_16x16x32_bf16 v[32:35], v[228:231], v[200:203], v[32:35]
    ds_read_b64_tr_b16 v[120:121], v106 offset:28672
    v_mfma_f32_16x16x32_bf16 v[36:39], v[232:235], v[200:203], v[36:39]
    ds_read_b64_tr_b16 v[122:123], v106 offset:30720
    buffer_load_dwordx4 v255, s[64:67], s69 offen offset:3072 lds
    s_mov_b32 s64, s48
    s_mov_b32 s65, s49
    s_mov_b32 s69, s30
    v_mfma_f32_16x16x32_bf16 v[40:43], v[236:239], v[200:203], v[40:43]
    ds_read_b64_tr_b16 v[124:125], v107 offset:28672
    v_mfma_f32_16x16x32_bf16 v[44:47], v[240:243], v[200:203], v[44:47]
    ds_read_b64_tr_b16 v[126:127], v107 offset:30720
    buffer_load_dwordx4 v[48:51], v176, s[12:15], s50 offen sc1
    buffer_load_dwordx4 v[52:55], v177, s[12:15], s50 offen sc1
    s_add_u32 s50, s50, 131072
    s_waitcnt vmcnt(22) lgkmcnt(8)
    v_mfma_f32_16x16x32_bf16 v[16:19], v[80:83], v[204:207], v[16:19]
    ds_read_b64_tr_b16 v[228:229], v104 offset:32768
    v_mfma_f32_16x16x32_bf16 v[20:23], v[84:87], v[204:207], v[20:23]
    ds_read_b64_tr_b16 v[230:231], v104 offset:34816
    s_mov_b32 m0, s32
    s_add_u32 s69, s69, 262144
    buffer_load_dwordx4 v252, s[64:67], s69 offen offset:0 lds
    v_mfma_f32_16x16x32_bf16 v[24:27], v[88:91], v[204:207], v[24:27]
    ds_read_b64_tr_b16 v[232:233], v105 offset:32768
    v_mfma_f32_16x16x32_bf16 v[28:31], v[92:95], v[204:207], v[28:31]
    ds_read_b64_tr_b16 v[234:235], v105 offset:34816
    v_mfma_f32_16x16x32_bf16 v[32:35], v[80:83], v[208:211], v[32:35]
    ds_read_b64_tr_b16 v[236:237], v106 offset:32768
    v_mfma_f32_16x16x32_bf16 v[36:39], v[84:87], v[208:211], v[36:39]
    ds_read_b64_tr_b16 v[238:239], v106 offset:34816
    buffer_load_dwordx4 v253, s[64:67], s69 offen offset:1024 lds
    v_mfma_f32_16x16x32_bf16 v[40:43], v[88:91], v[208:211], v[40:43]
    ds_read_b64_tr_b16 v[240:241], v107 offset:32768
    v_mfma_f32_16x16x32_bf16 v[44:47], v[92:95], v[208:211], v[44:47]
    ds_read_b64_tr_b16 v[242:243], v107 offset:34816
    buffer_load_dwordx4 v[128:131], v176, s[12:15], s50 offen sc1
    buffer_load_dwordx4 v[132:135], v177, s[12:15], s50 offen sc1
    s_add_u32 s50, s50, 131072
    s_waitcnt vmcnt(24) lgkmcnt(8)
    v_mfma_f32_16x16x32_bf16 v[16:19], v[112:115], v[220:223], v[16:19]
    ds_read_b64_tr_b16 v[80:81], v104 offset:36864
    v_mfma_f32_16x16x32_bf16 v[20:23], v[116:119], v[220:223], v[20:23]
    ds_read_b64_tr_b16 v[82:83], v104 offset:38912
    buffer_load_dwordx4 v254, s[64:67], s69 offen offset:2048 lds
    v_mfma_f32_16x16x32_bf16 v[24:27], v[120:123], v[220:223], v[24:27]
    ds_read_b64_tr_b16 v[84:85], v105 offset:36864
    v_mfma_f32_16x16x32_bf16 v[28:31], v[124:127], v[220:223], v[28:31]
    ds_read_b64_tr_b16 v[86:87], v105 offset:38912
    v_mfma_f32_16x16x32_bf16 v[32:35], v[112:115], v[224:227], v[32:35]
    ds_read_b64_tr_b16 v[88:89], v106 offset:36864
    v_mfma_f32_16x16x32_bf16 v[36:39], v[116:119], v[224:227], v[36:39]
    ds_read_b64_tr_b16 v[90:91], v106 offset:38912
    buffer_load_dwordx4 v255, s[64:67], s69 offen offset:3072 lds
    s_add_u32 s32, s32, 16384
    v_mfma_f32_16x16x32_bf16 v[40:43], v[120:123], v[224:227], v[40:43]
    ds_read_b64_tr_b16 v[92:93], v107 offset:36864
    v_mfma_f32_16x16x32_bf16 v[44:47], v[124:127], v[224:227], v[44:47]
    ds_read_b64_tr_b16 v[94:95], v107 offset:38912
    s_barrier
    s_cmp_lg_u32 s20, 7
    s_cbranch_scc1 Lp3_n7
    s_mov_b32 m0, 159744
    s_sub_u32 s69, s69, 262144
    buffer_load_dwordx4 v252, s[64:67], s69 offen offset:0 lds
    buffer_load_dwordx4 v253, s[64:67], s69 offen offset:1024 lds
    buffer_load_dwordx4 v254, s[64:67], s69 offen offset:2048 lds
    buffer_load_dwordx4 v255, s[64:67], s69 offen offset:3072 lds
    s_add_u32 s69, s69, 262144
Lp3_n7:
    s_waitcnt vmcnt(24) lgkmcnt(8)
    v_mfma_f32_16x16x32_bf16 v[16:19], v[228:231], v[212:215], v[16:19]
    ds_read_b64_tr_b16 v[112:113], v104 offset:40960
    v_mfma_f32_16x16x32_bf16 v[20:23], v[232:235], v[212:215], v[20:23]
    ds_read_b64_tr_b16 v[114:115], v104 offset:43008
    s_mov_b32 m0, s32
    s_add_u32 s69, s69, 262144
    buffer_load_dwordx4 v252, s[64:67], s69 offen offset:0 lds
    v_mfma_f32_16x16x32_bf16 v[24:27], v[236:239], v[212:215], v[24:27]
    ds_read_b64_tr_b16 v[116:117], v105 offset:40960
    v_mfma_f32_16x16x32_bf16 v[28:31], v[240:243], v[212:215], v[28:31]
    ds_read_b64_tr_b16 v[118:119], v105 offset:43008
    v_mfma_f32_16x16x32_bf16 v[32:35], v[228:231], v[216:219], v[32:35]
    ds_read_b64_tr_b16 v[120:121], v106 offset:40960
    v_mfma_f32_16x16x32_bf16 v[36:39], v[232:235], v[216:219], v[36:39]
    ds_read_b64_tr_b16 v[122:123], v106 offset:43008
    v_mfma_f32_16x16x32_bf16 v[40:43], v[236:239], v[216:219], v[40:43]
    ds_read_b64_tr_b16 v[124:125], v107 offset:40960
    v_mfma_f32_16x16x32_bf16 v[44:47], v[240:243], v[216:219], v[44:47]
    ds_read_b64_tr_b16 v[126:127], v107 offset:43008
    s_waitcnt vmcnt(21) lgkmcnt(8)
    v_mfma_f32_16x16x32_bf16 v[16:19], v[80:83], v[136:139], v[16:19]
    ds_read_b64_tr_b16 v[228:229], v104 offset:45056
    v_mfma_f32_16x16x32_bf16 v[20:23], v[84:87], v[136:139], v[20:23]
    ds_read_b64_tr_b16 v[230:231], v104 offset:47104
    buffer_load_dwordx4 v253, s[64:67], s69 offen offset:1024 lds
    v_mfma_f32_16x16x32_bf16 v[24:27], v[88:91], v[136:139], v[24:27]
    ds_read_b64_tr_b16 v[232:233], v105 offset:45056
    v_mfma_f32_16x16x32_bf16 v[28:31], v[92:95], v[136:139], v[28:31]
    ds_read_b64_tr_b16 v[234:235], v105 offset:47104
    v_mfma_f32_16x16x32_bf16 v[32:35], v[80:83], v[140:143], v[32:35]
    ds_read_b64_tr_b16 v[236:237], v106 offset:45056
    v_mfma_f32_16x16x32_bf16 v[36:39], v[84:87], v[140:143], v[36:39]
    ds_read_b64_tr_b16 v[238:239], v106 offset:47104
    v_mfma_f32_16x16x32_bf16 v[40:43], v[88:91], v[140:143], v[40:43]
    ds_read_b64_tr_b16 v[240:241], v107 offset:45056
    v_mfma_f32_16x16x32_bf16 v[44:47], v[92:95], v[140:143], v[44:47]
    ds_read_b64_tr_b16 v[242:243], v107 offset:47104
    s_waitcnt vmcnt(20) lgkmcnt(8)
    v_mfma_f32_16x16x32_bf16 v[16:19], v[112:115], v[96:99], v[16:19]
    ds_read_b64_tr_b16 v[80:81], v104 offset:49152
    v_mfma_f32_16x16x32_bf16 v[20:23], v[116:119], v[96:99], v[20:23]
    ds_read_b64_tr_b16 v[82:83], v104 offset:51200
    buffer_load_dwordx4 v254, s[64:67], s69 offen offset:2048 lds
    v_mfma_f32_16x16x32_bf16 v[24:27], v[120:123], v[96:99], v[24:27]
    ds_read_b64_tr_b16 v[84:85], v105 offset:49152
    v_mfma_f32_16x16x32_bf16 v[28:31], v[124:127], v[96:99], v[28:31]
    ds_read_b64_tr_b16 v[86:87], v105 offset:51200
    v_mfma_f32_16x16x32_bf16 v[32:35], v[112:115], v[100:103], v[32:35]
    ds_read_b64_tr_b16 v[88:89], v106 offset:49152
    v_mfma_f32_16x16x32_bf16 v[36:39], v[116:119], v[100:103], v[36:39]
    ds_read_b64_tr_b16 v[90:91], v106 offset:51200
    v_mfma_f32_16x16x32_bf16 v[40:43], v[120:123], v[100:103], v[40:43]
    ds_read_b64_tr_b16 v[92:93], v107 offset:49152
    v_mfma_f32_16x16x32_bf16 v[44:47], v[124:127], v[100:103], v[44:47]
    ds_read_b64_tr_b16 v[94:95], v107 offset:51200
    s_waitcnt vmcnt(19) lgkmcnt(8)
    v_mfma_f32_16x16x32_bf16 v[16:19], v[228:231], v[56:59], v[16:19]
    ds_read_b64_tr_b16 v[112:113], v104 offset:53248
    v_mfma_f32_16x16x32_bf16 v[20:23], v[232:235], v[56:59], v[20:23]
    ds_read_b64_tr_b16 v[114:115], v104 offset:55296
    buffer_load_dwordx4 v255, s[64:67], s69 offen offset:3072 lds
    s_add_u32 s32, s32, 16384
    v_mfma_f32_16x16x32_bf16 v[24:27], v[236:239], v[56:59], v[24:27]
    ds_read_b64_tr_b16 v[116:117], v105 offset:53248
    v_mfma_f32_16x16x32_bf16 v[28:31], v[240:243], v[56:59], v[28:31]
    ds_read_b64_tr_b16 v[118:119], v105 offset:55296
    v_mfma_f32_16x16x32_bf16 v[32:35], v[228:231], v[60:63], v[32:35]
    ds_read_b64_tr_b16 v[120:121], v106 offset:53248
    v_mfma_f32_16x16x32_bf16 v[36:39], v[232:235], v[60:63], v[36:39]
    ds_read_b64_tr_b16 v[122:123], v106 offset:55296
    v_mfma_f32_16x16x32_bf16 v[40:43], v[236:239], v[60:63], v[40:43]
    ds_read_b64_tr_b16 v[124:125], v107 offset:53248
    v_mfma_f32_16x16x32_bf16 v[44:47], v[240:243], v[60:63], v[44:47]
    ds_read_b64_tr_b16 v[126:127], v107 offset:55296
    s_cmp_lg_u32 s20, 0
    s_cbranch_scc1 Lp3_np
    s_mov_b32 s36, 65536
    s_add_u32 s28, s98, 3
Lpoll3:
    buffer_load_dword v9, v8, s[12:15], s101 offen sc1
    s_waitcnt vmcnt(0)
    v_subrev_u32 v9, s28, v9
    v_cmp_ge_u32 vcc, 0, v9
    s_sub_u32 s36, s36, 1
    s_cmp_eq_u64 vcc, -1
    s_cbranch_scc1 Lpoll3_ok
    s_sleep 2
    s_cmp_lg_u32 s36, 0
    s_cbranch_scc1 Lpoll3
Lpoll3_ok:
Lp3_np:
    s_waitcnt vmcnt(4)
    s_barrier
    s_add_u32 s50, s50, 2097152
    buffer_load_dwordx4 v[144:147], v176, s[12:15], s50 offen sc1
    buffer_load_dwordx4 v[148:151], v177, s[12:15], s50 offen sc1
    s_add_u32 s50, s50, 131072
    buffer_load_dwordx4 v[152:155], v176, s[12:15], s50 offen sc1
    buffer_load_dwordx4 v[156:159], v177, s[12:15], s50 offen sc1
    s_add_u32 s50, s50, 131072
    s_waitcnt vmcnt(22) lgkmcnt(8)
    v_mfma_f32_16x16x32_bf16 v[16:19], v[80:83], v[64:67], v[16:19]
    ds_read_b64_tr_b16 v[228:229], v104 offset:57344
    v_mfma_f32_16x16x32_bf16 v[20:23], v[84:87], v[64:67], v[20:23]
    ds_read_b64_tr_b16 v[230:231], v104 offset:59392
    s_mov_b32 m0, s32
    s_add_u32 s69, s69, 262144
    buffer_load_dwordx4 v252, s[64:67], s69 offen offset:0 lds
    v_mfma_f32_16x16x32_bf16 v[24:27], v[88:91], v[64:67], v[24:27]
    ds_read_b64_tr_b16 v[232:233], v105 offset:57344
    v_mfma_f32_16x16x32_bf16 v[28:31], v[92:95], v[64:67], v[28:31]
    ds_read_b64_tr_b16 v[234:235], v105 offset:59392
    v_mfma_f32_16x16x32_bf16 v[32:35], v[80:83], v[68:71], v[32:35]
    ds_read_b64_tr_b16 v[236:237], v106 offset:57344
    v_mfma_f32_16x16x32_bf16 v[36:39], v[84:87], v[68:71], v[36:39]
    ds_read_b64_tr_b16 v[238:239], v106 offset:59392
    v_mfma_f32_16x16x32_bf16 v[40:43], v[88:91], v[68:71], v[40:43]
    ds_read_b64_tr_b16 v[240:241], v107 offset:57344
    v_mfma_f32_16x16x32_bf16 v[44:47], v[92:95], v[68:71], v[44:47]
    ds_read_b64_tr_b16 v[242:243], v107 offset:59392
    buffer_load_dwordx4 v[160:163], v176, s[12:15], s50 offen sc1
    buffer_load_dwordx4 v[164:167], v177, s[12:15], s50 offen sc1
    s_add_u32 s50, s50, 131072
    s_waitcnt vmcnt(21) lgkmcnt(8)
    v_mfma_f32_16x16x32_bf16 v[16:19], v[112:115], v[72:75], v[16:19]
    ds_read_b64_tr_b16 v[80:81], v104 offset:61440
    v_mfma_f32_16x16x32_bf16 v[20:23], v[116:119], v[72:75], v[20:23]
    ds_read_b64_tr_b16 v[82:83], v104 offset:63488
    buffer_load_dwordx4 v253, s[64:67], s69 offen offset:1024 lds
    v_mfma_f32_16x16x32_bf16 v[24:27], v[120:123], v[72:75], v[24:27]
    ds_read_b64_tr_b16 v[84:85], v105 offset:61440
    v_mfma_f32_16x16x32_bf16 v[28:31], v[124:127], v[72:75], v[28:31]
    ds_read_b64_tr_b16 v[86:87], v105 offset:63488
    v_mfma_f32_16x16x32_bf16 v[32:35], v[112:115], v[76:79], v[32:35]
    ds_read_b64_tr_b16 v[88:89], v106 offset:61440
    v_mfma_f32_16x16x32_bf16 v[36:39], v[116:119], v[76:79], v[36:39]
    ds_read_b64_tr_b16 v[90:91], v106 offset:63488
    v_mfma_f32_16x16x32_bf16 v[40:43], v[120:123], v[76:79], v[40:43]
    ds_read_b64_tr_b16 v[92:93], v107 offset:61440
    v_mfma_f32_16x16x32_bf16 v[44:47], v[124:127], v[76:79], v[44:47]
    ds_read_b64_tr_b16 v[94:95], v107 offset:63488
    s_waitcnt vmcnt(18) lgkmcnt(8)
    v_mfma_f32_16x16x32_bf16 v[16:19], v[228:231], v[48:51], v[16:19]
    ds_read_b64_tr_b16 v[112:113], v108 offset:0
    v_mfma_f32_16x16x32_bf16 v[20:23], v[232:235], v[48:51], v[20:23]
    ds_read_b64_tr_b16 v[114:115], v108 offset:1024
    buffer_load_dwordx4 v254, s[64:67], s69 offen offset:2048 lds
    v_mfma_f32_16x16x32_bf16 v[24:27], v[236:239], v[48:51], v[24:27]
    ds_read_b64_tr_b16 v[116:117], v109 offset:0
    v_mfma_f32_16x16x32_bf16 v[28:31], v[240:243], v[48:51], v[28:31]
    ds_read_b64_tr_b16 v[118:119], v109 offset:1024
    v_mfma_f32_16x16x32_bf16 v[32:35], v[228:231], v[52:55], v[32:35]
    ds_read_b64_tr_b16 v[120:121], v110 offset:0
    v_mfma_f32_16x16x32_bf16 v[36:39], v[232:235], v[52:55], v[36:39]
    ds_read_b64_tr_b16 v[122:123], v110 offset:1024
    v_mfma_f32_16x16x32_bf16 v[40:43], v[236:239], v[52:55], v[40:43]
    ds_read_b64_tr_b16 v[124:125], v111 offset:0
    v_mfma_f32_16x16x32_bf16 v[44:47], v[240:243], v[52:55], v[44:47]
    ds_read_b64_tr_b16 v[126:127], v111 offset:1024
    buffer_load_dwordx4 v[168:171], v176, s[12:15], s50 offen sc1
    buffer_load_dwordx4 v[172:175], v177, s[12:15], s50 offen sc1
    s_add_u32 s50, s50, 131072
    s_waitcnt vmcnt(17) lgkmcnt(8)
    v_mfma_f32_16x16x32_bf16 v[16:19], v[80:83], v[128:131], v[16:19]
    ds_read_b64_tr_b16 v[228:229], v108 offset:4096
    v_mfma_f32_16x16x32_bf16 v[20:23], v[84:87], v[128:131], v[20:23]
    ds_read_b64_tr_b16 v[230:231], v108 offset:5120
    buffer_load_dwordx4 v255, s[64:67], s69 offen offset:3072 lds
    s_add_u32 s32, s32, 16384
    v_mfma_f32_16x16x32_bf16 v[24:27], v[88:91], v[128:131], v[24:27]
    ds_read_b64_tr_b16 v[232:233], v109 offset:4096
    v_mfma_f32_16x16x32_bf16 v[28:31], v[92:95], v[128:131], v[28:31]
    ds_read_b64_tr_b16 v[234:235], v109 offset:5120
    v_mfma_f32_16x16x32_bf16 v[32:35], v[80:83], v[132:135], v[32:35]
    ds_read_b64_tr_b16 v[236:237], v110 offset:4096
    v_mfma_f32_16x16x32_bf16 v[36:39], v[84:87], v[132:135], v[36:39]
    ds_read_b64_tr_b16 v[238:239], v110 offset:5120
    v_mfma_f32_16x16x32_bf16 v[40:43], v[88:91], v[132:135], v[40:43]
    ds_read_b64_tr_b16 v[240:241], v111 offset:4096
    v_mfma_f32_16x16x32_bf16 v[44:47], v[92:95], v[132:135], v[44:47]
    ds_read_b64_tr_b16 v[242:243], v111 offset:5120
    s_waitcnt vmcnt(10) lgkmcnt(8)
    v_mfma_f32_16x16x32_bf16 v[48:51], v[112:115], v[144:147], 0
    ds_read_b64_tr_b16 v[80:81], v108 offset:8192
    v_mfma_f32_16x16x32_bf16 v[52:55], v[116:119], v[144:147], 0
    ds_read_b64_tr_b16 v[82:83], v108 offset:9216
    v_mfma_f32_16x16x32_bf16 v[56:59], v[120:123], v[144:147], 0
    ds_read_b64_tr_b16 v[84:85], v109 offset:8192
    v_mfma_f32_16x16x32_bf16 v[60:63], v[124:127], v[144:147], 0
    ds_read_b64_tr_b16 v[86:87], v109 offset:9216
    v_mfma_f32_16x16x32_bf16 v[64:67], v[112:115], v[148:151], 0
    ds_read_b64_tr_b16 v[88:89], v110 offset:8192
    v_mfma_f32_16x16x32_bf16 v[68:71], v[116:119], v[148:151], 0
    ds_read_b64_tr_b16 v[90:91], v110 offset:9216
    v_mfma_f32_16x16x32_bf16 v[72:75], v[120:123], v[148:151], 0
    ds_read_b64_tr_b16 v[92:93], v111 offset:8192
    v_mfma_f32_16x16x32_bf16 v[76:79], v[124:127], v[148:151], 0
    ds_read_b64_tr_b16 v[94:95], v111 offset:9216
    buffer_load_dwordx4 v[196:199], v176, s[12:15], s50 offen sc1
    buffer_load_dwordx4 v[200:203], v177, s[12:15], s50 offen sc1
    s_add_u32 s50, s50, 131072
    s_lshl_b32 s26, s43, 6
    v_add_u32 v9, s26, v8
    v_xor_b32 v11, 64, v9
    buffer_load_dword v178, v9, s[12:15], s53 offen sc1
    buffer_load_dword v179, v11, s[12:15], s53 offen sc1
    s_waitcnt vmcnt(12) lgkmcnt(8)
    v_mfma_f32_16x16x32_bf16 v[48:51], v[228:231], v[152:155], v[48:51]
    ds_read_b64_tr_b16 v[112:113], v108 offset:12288
    v_mfma_f32_16x16x32_bf16 v[52:55], v[232:235], v[152:155], v[52:55]
    ds_read_b64_tr_b16 v[114:115], v108 offset:13312
    v_mfma_f32_16x16x32_bf16 v[56:59], v[236:239], v[152:155], v[56:59]
    ds_read_b64_tr_b16 v[116:117], v109 offset:12288
    v_mfma_f32_16x16x32_bf16 v[60:63], v[240:243], v[152:155], v[60:63]
    ds_read_b64_tr_b16 v[118:119], v109 offset:13312
    v_mfma_f32_16x16x32_bf16 v[64:67], v[228:231], v[156:159], v[64:67]
    ds_read_b64_tr_b16 v[120:121], v110 offset:12288
    v_mfma_f32_16x16x32_bf16 v[68:71], v[232:235], v[156:159], v[68:71]
    ds_read_b64_tr_b16 v[122:123], v110 offset:13312
    v_mfma_f32_16x16x32_bf16 v[72:75], v[236:239], v[156:159], v[72:75]
    ds_read_b64_tr_b16 v[124:125], v111 offset:12288
    v_mfma_f32_16x16x32_bf16 v[76:79], v[240:243], v[156:159], v[76:79]
    ds_read_b64_tr_b16 v[126:127], v111 offset:13312
    buffer_load_dwordx4 v[204:207], v176, s[12:15], s50 offen sc1
    buffer_load_dwordx4 v[208:211], v177, s[12:15], s50 offen sc1
    s_add_u32 s50, s50, 131072
    s_mul_i32 s26, s43, 49152
    s_sub_u32 s26, s26, 131072
    v_add_u32 v108, s26, v108
    v_add_u32 v109, s26, v109
    v_add_u32 v110, s26, v110
    v_add_u32 v111, s26, v111
    s_waitcnt vmcnt(11) lgkmcnt(8)
    v_mfma_f32_16x16x32_bf16 v[48:51], v[80:83], v[160:163], v[48:51]
    ds_read_b64_tr_b16 v[228:229], v108 offset:0
    v_mfma_f32_16x16x32_bf16 v[52:55], v[84:87], v[160:163], v[52:55]
    ds_read_b64_tr_b16 v[230:231], v108 offset:1024
    v_mfma_f32_16x16x32_bf16 v[56:59], v[88:91], v[160:163], v[56:59]
    ds_read_b64_tr_b16 v[232:233], v109 offset:0
    v_mfma_f32_16x16x32_bf16 v[60:63], v[92:95], v[160:163], v[60:63]
    ds_read_b64_tr_b16 v[234:235], v109 offset:1024
    v_mfma_f32_16x16x32_bf16 v[64:67], v[80:83], v[164:167], v[64:67]
    ds_read_b64_tr_b16 v[236:237], v110 offset:0
    v_mfma_f32_16x16x32_bf16 v[68:71], v[84:87], v[164:167], v[68:71]
    ds_read_b64_tr_b16 v[238:239], v110 offset:1024
    v_mfma_f32_16x16x32_bf16 v[72:75], v[88:91], v[164:167], v[72:75]
    ds_read_b64_tr_b16 v[240:241], v111 offset:0
    v_mfma_f32_16x16x32_bf16 v[76:79], v[92:95], v[164:167], v[76:79]
    ds_read_b64_tr_b16 v[242:243], v111 offset:1024
    buffer_load_dwordx4 v[220:223], v176, s[12:15], s50 offen sc1
    buffer_load_dwordx4 v[224:227], v177, s[12:15], s50 offen sc1
    s_add_u32 s50, s50, 131072
    s_waitcnt vmcnt(9) lgkmcnt(8)
    v_mfma_f32_16x16x32_bf16 v[48:51], v[112:115], v[168:171], v[48:51]
    ds_read_b64_tr_b16 v[80:81], v108 offset:4096
    v_mfma_f32_16x16x32_bf16 v[52:55], v[116:119], v[168:171], v[52:55]
    ds_read_b64_tr_b16 v[82:83], v108 offset:5120
    v_mfma_f32_16x16x32_bf16 v[56:59], v[120:123], v[168:171], v[56:59]
    ds_read_b64_tr_b16 v[84:85], v109 offset:4096
    v_mfma_f32_16x16x32_bf16 v[60:63], v[124:127], v[168:171], v[60:63]
    ds_read_b64_tr_b16 v[86:87], v109 offset:5120
    v_mfma_f32_16x16x32_bf16 v[64:67], v[112:115], v[172:175], v[64:67]
    ds_read_b64_tr_b16 v[88:89], v110 offset:4096
    v_mfma_f32_16x16x32_bf16 v[68:71], v[116:119], v[172:175], v[68:71]
    ds_read_b64_tr_b16 v[90:91], v110 offset:5120
    v_mfma_f32_16x16x32_bf16 v[72:75], v[120:123], v[172:175], v[72:75]
    ds_read_b64_tr_b16 v[92:93], v111 offset:4096
    v_mfma_f32_16x16x32_bf16 v[76:79], v[124:127], v[172:175], v[76:79]
    ds_read_b64_tr_b16 v[94:95], v111 offset:5120
    buffer_load_dwordx4 v[212:215], v176, s[12:15], s50 offen sc1
    buffer_load_dwordx4 v[216:219], v177, s[12:15], s50 offen sc1
    s_add_u32 s50, s50, 131072
    s_waitcnt vmcnt(8) lgkmcnt(8)
    v_mfma_f32_16x16x32_bf16 v[48:51], v[228:231], v[196:199], v[48:51]
    ds_read_b64_tr_b16 v[112:113], v108 offset:8192
    v_mfma_f32_16x16x32_bf16 v[52:55], v[232:235], v[196:199], v[52:55]
    ds_read_b64_tr_b16 v[114:115], v108 offset:9216
    v_mfma_f32_16x16x32_bf16 v[56:59], v[236:239], v[196:199], v[56:59]
    ds_read_b64_tr_b16 v[116:117], v109 offset:8192
    v_mfma_f32_16x16x32_bf16 v[60:63], v[240:243], v[196:199], v[60:63]
    ds_read_b64_tr_b16 v[118:119], v109 offset:9216
    v_mfma_f32_16x16x32_bf16 v[64:67], v[228:231], v[200:203], v[64:67]
    ds_read_b64_tr_b16 v[120:121], v110 offset:8192
    v_mfma_f32_16x16x32_bf16 v[68:71], v[232:235], v[200:203], v[68:71]
    ds_read_b64_tr_b16 v[122:123], v110 offset:9216
    v_mfma_f32_16x16x32_bf16 v[72:75], v[236:239], v[200:203], v[72:75]
    ds_read_b64_tr_b16 v[124:125], v111 offset:8192
    v_mfma_f32_16x16x32_bf16 v[76:79], v[240:243], v[200:203], v[76:79]
    ds_read_b64_tr_b16 v[126:127], v111 offset:9216
    buffer_load_dwordx4 v[136:139], v176, s[12:15], s50 offen sc1
    buffer_load_dwordx4 v[140:143], v177, s[12:15], s50 offen sc1
    s_add_u32 s50, s50, 131072
    s_waitcnt vmcnt(6) lgkmcnt(8)
    v_mfma_f32_16x16x32_bf16 v[48:51], v[80:83], v[204:207], v[48:51]
    ds_read_b64_tr_b16 v[228:229], v108 offset:12288
    v_mfma_f32_16x16x32_bf16 v[52:55], v[84:87], v[204:207], v[52:55]
    ds_read_b64_tr_b16 v[230:231], v108 offset:13312
    v_mfma_f32_16x16x32_bf16 v[56:59], v[88:91], v[204:207], v[56:59]
    ds_read_b64_tr_b16 v[232:233], v109 offset:12288
    v_mfma_f32_16x16x32_bf16 v[60:63], v[92:95], v[204:207], v[60:63]
    ds_read_b64_tr_b16 v[234:235], v109 offset:13312
    v_mfma_f32_16x16x32_bf16 v[64:67], v[80:83], v[208:211], v[64:67]
    ds_read_b64_tr_b16 v[236:237], v110 offset:12288
    v_mfma_f32_16x16x32_bf16 v[68:71], v[84:87], v[208:211], v[68:71]
    ds_read_b64_tr_b16 v[238:239], v110 offset:13312
    v_mfma_f32_16x16x32_bf16 v[72:75], v[88:91], v[208:211], v[72:75]
    ds_read_b64_tr_b16 v[240:241], v111 offset:12288
    v_mfma_f32_16x16x32_bf16 v[76:79], v[92:95], v[208:211], v[76:79]
    ds_read_b64_tr_b16 v[242:243], v111 offset:13312
    buffer_load_dwordx4 v[96:99], v176, s[12:15], s50 offen sc1
    buffer_load_dwordx4 v[100:103], v177, s[12:15], s50 offen sc1
    s_add_u32 s50, s50, 131072
    s_waitcnt vmcnt(10)
    s_barrier
    v_sub_f32 v244, 1.0, v178
    v_sub_f32 v245, 1.0, v179
    s_waitcnt vmcnt(6) lgkmcnt(8)
    v_mfma_f32_16x16x32_bf16 v[48:51], v[112:115], v[220:223], v[48:51]
    ds_read_b64_tr_b16 v[80:81], v108 offset:16384
    v_mfma_f32_16x16x32_bf16 v[52:55], v[116:119], v[220:223], v[52:55]
    ds_read_b64_tr_b16 v[82:83], v108 offset:17408
    v_mfma_f32_16x16x32_bf16 v[56:59], v[120:123], v[220:223], v[56:59]
    ds_read_b64_tr_b16 v[84:85], v109 offset:16384
    v_mfma_f32_16x16x32_bf16 v[60:63], v[124:127], v[220:223], v[60:63]
    ds_read_b64_tr_b16 v[86:87], v109 offset:17408
    v_mfma_f32_16x16x32_bf16 v[64:67], v[112:115], v[224:227], v[64:67]
    ds_read_b64_tr_b16 v[88:89], v110 offset:16384
    v_mfma_f32_16x16x32_bf16 v[68:71], v[116:119], v[224:227], v[68:71]
    ds_read_b64_tr_b16 v[90:91], v110 offset:17408
    v_mfma_f32_16x16x32_bf16 v[72:75], v[120:123], v[224:227], v[72:75]
    ds_read_b64_tr_b16 v[92:93], v111 offset:16384
    v_mfma_f32_16x16x32_bf16 v[76:79], v[124:127], v[224:227], v[76:79]
    ds_read_b64_tr_b16 v[94:95], v111 offset:17408
    buffer_load_dwordx4 v[180:183], v176, s[12:15], s50 offen sc1
    buffer_load_dwordx4 v[184:187], v177, s[12:15], s50 offen sc1
    s_add_u32 s50, s50, 131072
    s_waitcnt vmcnt(6) lgkmcnt(8)
    v_mfma_f32_16x16x32_bf16 v[48:51], v[228:231], v[212:215], v[48:51]
    ds_read_b64_tr_b16 v[112:113], v108 offset:20480
    v_mfma_f32_16x16x32_bf16 v[52:55], v[232:235], v[212:215], v[52:55]
    ds_read_b64_tr_b16 v[114:115], v108 offset:21504
    v_mfma_f32_16x16x32_bf16 v[56:59], v[236:239], v[212:215], v[56:59]
    ds_read_b64_tr_b16 v[116:117], v109 offset:20480
    v_mfma_f32_16x16x32_bf16 v[60:63], v[240:243], v[212:215], v[60:63]
    ds_read_b64_tr_b16 v[118:119], v109 offset:21504
    v_mfma_f32_16x16x32_bf16 v[64:67], v[228:231], v[216:219], v[64:67]
    ds_read_b64_tr_b16 v[120:121], v110 offset:20480
    v_mfma_f32_16x16x32_bf16 v[68:71], v[232:235], v[216:219], v[68:71]
    ds_read_b64_tr_b16 v[122:123], v110 offset:21504
    v_mfma_f32_16x16x32_bf16 v[72:75], v[236:239], v[216:219], v[72:75]
    ds_read_b64_tr_b16 v[124:125], v111 offset:20480
    v_mfma_f32_16x16x32_bf16 v[76:79], v[240:243], v[216:219], v[76:79]
    ds_read_b64_tr_b16 v[126:127], v111 offset:21504
    buffer_load_dwordx4 v[188:191], v176, s[12:15], s50 offen sc1
    buffer_load_dwordx4 v[192:195], v177, s[12:15], s50 offen sc1
    s_add_u32 s50, s50, 131072
    s_waitcnt vmcnt(6) lgkmcnt(8)
    v_mfma_f32_16x16x32_bf16 v[48:51], v[80:83], v[136:139], v[48:51]
    ds_read_b64_tr_b16 v[228:229], v108 offset:24576
    v_mfma_f32_16x16x32_bf16 v[52:55], v[84:87], v[136:139], v[52:55]
    ds_read_b64_tr_b16 v[230:231], v108 offset:25600
    v_mfma_f32_16x16x32_bf16 v[56:59], v[88:91], v[136:139], v[56:59]
    ds_read_b64_tr_b16 v[232:233], v109 offset:24576
    v_mfma_f32_16x16x32_bf16 v[60:63], v[92:95], v[136:139], v[60:63]
    ds_read_b64_tr_b16 v[234:235], v109 offset:25600
    v_mfma_f32_16x16x32_bf16 v[64:67], v[80:83], v[140:143], v[64:67]
    ds_read_b64_tr_b16 v[236:237], v110 offset:24576
    v_mfma_f32_16x16x32_bf16 v[68:71], v[84:87], v[140:143], v[68:71]
    ds_read_b64_tr_b16 v[238:239], v110 offset:25600
    v_mfma_f32_16x16x32_bf16 v[72:75], v[88:91], v[140:143], v[72:75]
    ds_read_b64_tr_b16 v[240:241], v111 offset:24576
    v_mfma_f32_16x16x32_bf16 v[76:79], v[92:95], v[140:143], v[76:79]
    ds_read_b64_tr_b16 v[242:243], v111 offset:25600
    buffer_load_dwordx4 v[128:131], v176, s[12:15], s50 offen sc1
    buffer_load_dwordx4 v[132:135], v177, s[12:15], s50 offen sc1
    s_add_u32 s50, s50, 131072
    s_waitcnt vmcnt(6) lgkmcnt(8)
    v_mfma_f32_16x16x32_bf16 v[48:51], v[112:115], v[96:99], v[48:51]
    ds_read_b64_tr_b16 v[80:81], v108 offset:28672
    v_mfma_f32_16x16x32_bf16 v[52:55], v[116:119], v[96:99], v[52:55]
    ds_read_b64_tr_b16 v[82:83], v108 offset:29696
    v_mfma_f32_16x16x32_bf16 v[56:59], v[120:123], v[96:99], v[56:59]
    ds_read_b64_tr_b16 v[84:85], v109 offset:28672
    v_mfma_f32_16x16x32_bf16 v[60:63], v[124:127], v[96:99], v[60:63]
    ds_read_b64_tr_b16 v[86:87], v109 offset:29696
    v_mfma_f32_16x16x32_bf16 v[64:67], v[112:115], v[100:103], v[64:67]
    ds_read_b64_tr_b16 v[88:89], v110 offset:28672
    v_mfma_f32_16x16x32_bf16 v[68:71], v[116:119], v[100:103], v[68:71]
    ds_read_b64_tr_b16 v[90:91], v110 offset:29696
    v_mfma_f32_16x16x32_bf16 v[72:75], v[120:123], v[100:103], v[72:75]
    ds_read_b64_tr_b16 v[92:93], v111 offset:28672
    v_mfma_f32_16x16x32_bf16 v[76:79], v[124:127], v[100:103], v[76:79]
    ds_read_b64_tr_b16 v[94:95], v111 offset:29696
    buffer_load_dwordx4 v[144:147], v176, s[12:15], s50 offen sc1
    buffer_load_dwordx4 v[148:151], v177, s[12:15], s50 offen sc1
    s_add_u32 s50, s50, 131072
    s_waitcnt vmcnt(6) lgkmcnt(8)
    v_mfma_f32_16x16x32_bf16 v[48:51], v[228:231], v[180:183], v[48:51]
    ds_read_b64_tr_b16 v[112:113], v108 offset:32768
    v_mfma_f32_16x16x32_bf16 v[52:55], v[232:235], v[180:183], v[52:55]
    ds_read_b64_tr_b16 v[114:115], v108 offset:33792
    v_mfma_f32_16x16x32_bf16 v[56:59], v[236:239], v[180:183], v[56:59]
    ds_read_b64_tr_b16 v[116:117], v109 offset:32768
    v_mfma_f32_16x16x32_bf16 v[60:63], v[240:243], v[180:183], v[60:63]
    ds_read_b64_tr_b16 v[118:119], v109 offset:33792
    v_mfma_f32_16x16x32_bf16 v[64:67], v[228:231], v[184:187], v[64:67]
    ds_read_b64_tr_b16 v[120:121], v110 offset:32768
    v_mfma_f32_16x16x32_bf16 v[68:71], v[232:235], v[184:187], v[68:71]
    ds_read_b64_tr_b16 v[122:123], v110 offset:33792
    v_mfma_f32_16x16x32_bf16 v[72:75], v[236:239], v[184:187], v[72:75]
    ds_read_b64_tr_b16 v[124:125], v111 offset:32768
    v_mfma_f32_16x16x32_bf16 v[76:79], v[240:243], v[184:187], v[76:79]
    ds_read_b64_tr_b16 v[126:127], v111 offset:33792
    buffer_load_dwordx4 v[152:155], v176, s[12:15], s50 offen sc1
    buffer_load_dwordx4 v[156:159], v177, s[12:15], s50 offen sc1
    s_add_u32 s50, s50, 131072
    s_waitcnt vmcnt(6) lgkmcnt(8)
    v_mfma_f32_16x16x32_bf16 v[48:51], v[80:83], v[188:191], v[48:51]
    ds_read_b64_tr_b16 v[228:229], v108 offset:36864
    v_mul_f32 v16, v16, v244
    v_mfma_f32_16x16x32_bf16 v[52:55], v[84:87], v[188:191], v[52:55]
    ds_read_b64_tr_b16 v[230:231], v108 offset:37888
    v_mul_f32 v17, v17, v244
    v_mfma_f32_16x16x32_bf16 v[56:59], v[88:91], v[188:191], v[56:59]
    ds_read_b64_tr_b16 v[232:233], v109 offset:36864
    v_mul_f32 v18, v18, v244
    v_mfma_f32_16x16x32_bf16 v[60:63], v[92:95], v[188:191], v[60:63]
    ds_read_b64_tr_b16 v[234:235], v109 offset:37888
    v_mul_f32 v19, v19, v244
    v_mfma_f32_16x16x32_bf16 v[64:67], v[80:83], v[192:195], v[64:67]
    ds_read_b64_tr_b16 v[236:237], v110 offset:36864
    v_mul_f32 v20, v20, v244
    v_mfma_f32_16x16x32_bf16 v[68:71], v[84:87], v[192:195], v[68:71]
    ds_read_b64_tr_b16 v[238:239], v110 offset:37888
    v_mul_f32 v21, v21, v244
    v_mfma_f32_16x16x32_bf16 v[72:75], v[88:91], v[192:195], v[72:75]
    ds_read_b64_tr_b16 v[240:241], v111 offset:36864
    v_mul_f32 v22, v22, v244
    v_mfma_f32_16x16x32_bf16 v[76:79], v[92:95], v[192:195], v[76:79]
    ds_read_b64_tr_b16 v[242:243], v111 offset:37888
    v_mul_f32 v23, v23, v244
    buffer_load_dwordx4 v[160:163], v176, s[12:15], s50 offen sc1
    buffer_load_dwordx4 v[164:167], v177, s[12:15], s50 offen sc1
    s_add_u32 s50, s50, 131072
    s_waitcnt vmcnt(6) lgkmcnt(8)
    v_mfma_f32_16x16x32_bf16 v[48:51], v[112:115], v[128:131], v[48:51]
    ds_read_b64_tr_b16 v[80:81], v108 offset:40960
    v_mul_f32 v24, v24, v244
    v_mfma_f32_16x16x32_bf16 v[52:55], v[116:119], v[128:131], v[52:55]
    ds_read_b64_tr_b16 v[82:83], v108 offset:41984
    v_mul_f32 v25, v25, v244
    v_mfma_f32_16x16x32_bf16 v[56:59], v[120:123], v[128:131], v[56:59]
    ds_read_b64_tr_b16 v[84:85], v109 offset:40960
    v_mul_f32 v26, v26, v244
    v_mfma_f32_16x16x32_bf16 v[60:63], v[124:127], v[128:131], v[60:63]
    ds_read_b64_tr_b16 v[86:87], v109 offset:41984
    v_mul_f32 v27, v27, v244
    v_mfma_f32_16x16x32_bf16 v[64:67], v[112:115], v[132:135], v[64:67]
    ds_read_b64_tr_b16 v[88:89], v110 offset:40960
    v_mul_f32 v28, v28, v244
    v_mfma_f32_16x16x32_bf16 v[68:71], v[116:119], v[132:135], v[68:71]
    ds_read_b64_tr_b16 v[90:91], v110 offset:41984
    v_mul_f32 v29, v29, v244
    v_mfma_f32_16x16x32_bf16 v[72:75], v[120:123], v[132:135], v[72:75]
    ds_read_b64_tr_b16 v[92:93], v111 offset:40960
    v_mul_f32 v30, v30, v244
    v_mfma_f32_16x16x32_bf16 v[76:79], v[124:127], v[132:135], v[76:79]
    ds_read_b64_tr_b16 v[94:95], v111 offset:41984
    v_mul_f32 v31, v31, v244
    s_waitcnt vmcnt(4) lgkmcnt(8)
    v_mfma_f32_16x16x32_bf16 v[48:51], v[228:231], v[144:147], v[48:51]
    ds_read_b64_tr_b16 v[112:113], v108 offset:45056
    v_mul_f32 v32, v32, v245
    v_mfma_f32_16x16x32_bf16 v[52:55], v[232:235], v[144:147], v[52:55]
    ds_read_b64_tr_b16 v[114:115], v108 offset:46080
    v_mul_f32 v33, v33, v245
    v_mfma_f32_16x16x32_bf16 v[56:59], v[236:239], v[144:147], v[56:59]
    ds_read_b64_tr_b16 v[116:117], v109 offset:45056
    v_mul_f32 v34, v34, v245
    v_mfma_f32_16x16x32_bf16 v[60:63], v[240:243], v[144:147], v[60:63]
    ds_read_b64_tr_b16 v[118:119], v109 offset:46080
    v_mul_f32 v35, v35, v245
    v_mfma_f32_16x16x32_bf16 v[64:67], v[228:231], v[148:151], v[64:67]
    ds_read_b64_tr_b16 v[120:121], v110 offset:45056
    v_mul_f32 v36, v36, v245
    v_mfma_f32_16x16x32_bf16 v[68:71], v[232:235], v[148:151], v[68:71]
    ds_read_b64_tr_b16 v[122:123], v110 offset:46080
    v_mul_f32 v37, v37, v245
    v_mfma_f32_16x16x32_bf16 v[72:75], v[236:239], v[148:151], v[72:75]
    ds_read_b64_tr_b16 v[124:125], v111 offset:45056
    v_mul_f32 v38, v38, v245
    v_mfma_f32_16x16x32_bf16 v[76:79], v[240:243], v[148:151], v[76:79]
    ds_read_b64_tr_b16 v[126:127], v111 offset:46080
    v_mul_f32 v39, v39, v245
    s_waitcnt vmcnt(2) lgkmcnt(8)
    v_mfma_f32_16x16x32_bf16 v[48:51], v[80:83], v[152:155], v[48:51]
    v_mul_f32 v40, v40, v245
    v_mfma_f32_16x16x32_bf16 v[52:55], v[84:87], v[152:155], v[52:55]
    v_mul_f32 v41, v41, v245
    v_mfma_f32_16x16x32_bf16 v[56:59], v[88:91], v[152:155], v[56:59]
    v_mul_f32 v42, v42, v245
    v_mfma_f32_16x16x32_bf16 v[60:63], v[92:95], v[152:155], v[60:63]
    v_mul_f32 v43, v43, v245
    v_mfma_f32_16x16x32_bf16 v[64:67], v[80:83], v[156:159], v[64:67]
    v_mul_f32 v44, v44, v245
    v_mfma_f32_16x16x32_bf16 v[68:71], v[84:87], v[156:159], v[68:71]
    v_mul_f32 v45, v45, v245
    v_mfma_f32_16x16x32_bf16 v[72:75], v[88:91], v[156:159], v[72:75]
    v_mul_f32 v46, v46, v245
    v_mfma_f32_16x16x32_bf16 v[76:79], v[92:95], v[156:159], v[76:79]
    v_mul_f32 v47, v47, v245
    s_waitcnt vmcnt(0) lgkmcnt(0)
    v_mfma_f32_16x16x32_bf16 v[48:51], v[112:115], v[160:163], v[48:51]
    v_mfma_f32_16x16x32_bf16 v[52:55], v[116:119], v[160:163], v[52:55]
    v_mfma_f32_16x16x32_bf16 v[56:59], v[120:123], v[160:163], v[56:59]
    v_mfma_f32_16x16x32_bf16 v[60:63], v[124:127], v[160:163], v[60:63]
    v_mfma_f32_16x16x32_bf16 v[64:67], v[112:115], v[164:167], v[64:67]
    v_mfma_f32_16x16x32_bf16 v[68:71], v[116:119], v[164:167], v[68:71]
    v_mfma_f32_16x16x32_bf16 v[72:75], v[120:123], v[164:167], v[72:75]
    v_mfma_f32_16x16x32_bf16 v[76:79], v[124:127], v[164:167], v[76:79]
    s_and_b32 s26, s20, 3
    s_add_u32 s26, s26, 12
    s_lshl_b32 s26, s26, 12
    s_lshl_b32 s27, s43, 16
    s_add_u32 s27, s27, s26
    s_xor_b32 s26, s27, 65536
    v_add_u32 v4, s27, v12
    v_add_u32 v5, s26, v12
    v_fmac_f32 v32, v64, v179
    v_fmac_f32 v33, v65, v179
    v_fmac_f32 v34, v66, v179
    v_fmac_f32 v35, v67, v179
    ds_write_b128 v4, v[32:35] offset:0
    v_fmac_f32 v36, v68, v179
    v_fmac_f32 v37, v69, v179
    v_fmac_f32 v38, v70, v179
    v_fmac_f32 v39, v71, v179
    ds_write_b128 v4, v[36:39] offset:1024
    v_fmac_f32 v40, v72, v179
    v_fmac_f32 v41, v73, v179
    v_fmac_f32 v42, v74, v179
    v_fmac_f32 v43, v75, v179
    ds_write_b128 v4, v[40:43] offset:2048
    v_fmac_f32 v44, v76, v179
    v_fmac_f32 v45, v77, v179
    v_fmac_f32 v46, v78, v179
    v_fmac_f32 v47, v79, v179
    ds_write_b128 v4, v[44:47] offset:3072
    v_fmac_f32 v16, v48, v178
    v_fmac_f32 v17, v49, v178
    v_fmac_f32 v18, v50, v178
    v_fmac_f32 v19, v51, v178
    v_fmac_f32 v20, v52, v178
    v_fmac_f32 v21, v53, v178
    v_fmac_f32 v22, v54, v178
    v_fmac_f32 v23, v55, v178
    v_fmac_f32 v24, v56, v178
    v_fmac_f32 v25, v57, v178
    v_fmac_f32 v26, v58, v178
    v_fmac_f32 v27, v59, v178
    v_fmac_f32 v28, v60, v178
    v_fmac_f32 v29, v61, v178
    v_fmac_f32 v30, v62, v178
    v_fmac_f32 v31, v63, v178
    s_waitcnt lgkmcnt(0)
    s_barrier
    ds_read_b128 v[48:51], v5 offset:0
    ds_read_b128 v[52:55], v5 offset:1024
    ds_read_b128 v[56:59], v5 offset:2048
    ds_read_b128 v[60:63], v5 offset:3072
    s_waitcnt lgkmcnt(3)
    v_add_f32 v16, v16, v48
    v_add_f32 v17, v17, v49
    v_add_f32 v18, v18, v50
    v_add_f32 v19, v19, v51
    s_waitcnt lgkmcnt(2)
    v_add_f32 v20, v20, v52
    v_add_f32 v21, v21, v53
    v_add_f32 v22, v22, v54
    v_add_f32 v23, v23, v55
    v_cvt_pk_bf16_f32 v80, v16, v17
    v_cvt_pk_bf16_f32 v81, v18, v19
    v_cvt_pk_bf16_f32 v82, v20, v21
    v_cvt_pk_bf16_f32 v83, v22, v23
    s_nop 1
    v_permlane16_swap_b32 v80, v82
    v_permlane16_swap_b32 v81, v83
    buffer_store_dwordx4 v[80:83], v251, s[4:7], s52 offen offset:0 sc1
    s_waitcnt lgkmcnt(1)
    v_add_f32 v24, v24, v56
    v_add_f32 v25, v25, v57
    v_add_f32 v26, v26, v58
    v_add_f32 v27, v27, v59
    s_waitcnt lgkmcnt(0)
    v_add_f32 v28, v28, v60
    v_add_f32 v29, v29, v61
    v_add_f32 v30, v30, v62
    v_add_f32 v31, v31, v63
    v_cvt_pk_bf16_f32 v84, v24, v25
    v_cvt_pk_bf16_f32 v85, v26, v27
    v_cvt_pk_bf16_f32 v86, v28, v29
    v_cvt_pk_bf16_f32 v87, v30, v31
    s_nop 1
    v_permlane16_swap_b32 v84, v86
    v_permlane16_swap_b32 v85, v87
    buffer_store_dwordx4 v[84:87], v251, s[4:7], s52 offen offset:64 sc1
Lend:
    s_endpgm
Levent:
    s_cmp_eq_u32 s37, 7
    s_cbranch_scc1 Lflag2
    s_cmp_eq_u32 s37, 6
    s_cbranch_scc1 Lwoon
    s_cmp_eq_u32 s37, 5
    s_cbranch_scc0 Levent1
    s_mov_b32 s51, 2
    s_setprio 2
    s_branch Levent_ret
Levent1:
    s_setprio 1
    s_branch Levent_ret
Lflag2:
    s_mov_b32 s51, 6
    v_mov_b32 v9, 1
    s_mov_b64 exec, 1
    ds_add_rtn_u32 v9, v10, v9
    s_waitcnt lgkmcnt(0)
    v_readfirstlane_b32 s26, v9
    s_mov_b64 exec, -1
    s_cmp_lg_u32 s26, 7
    s_cbranch_scc1 Levent_ret
    s_add_u32 s36, s98, 2
    v_mov_b32 v9, s36
    s_mov_b64 exec, 1
    buffer_store_dword v9, off, s[12:15], s100 sc1
    s_mov_b64 exec, -1
    s_branch Levent_ret
Lwoon:
    s_mov_b32 s51, 5
    s_lshl_b32 s69, s20, 18
    s_add_u32 s69, s69, s71
    s_lshl_b32 s32, s20, 14
    s_cmp_gt_u32 s20, 1
    s_cbranch_scc1 Levent_ret
    s_mov_b32 s36, 524288
    s_setprio 0
Lwoon1:
    ds_read_b32 v9, v10
    s_waitcnt lgkmcnt(0)
    v_readfirstlane_b32 s26, v9
    s_sub_u32 s36, s36, 1
    s_cselect_b32 s26, 8, s26
    s_cmp_ge_u32 s26, 8
    s_cbranch_scc1 Lwoon2
    s_sleep 1
    s_branch Lwoon1
Lwoon2:
    s_setprio 3
    s_branch Levent_ret
Lnon2:
    s_mov_b32 s36, 65536
Lnon4:
    s_waitcnt vmcnt(0)
    v_readfirstlane_b32 s98, v13
    s_sub_u32 s36, s36, 1
    s_cselect_b32 s98, 4, s98
    s_cmp_lg_u32 s98, 0
    s_cbranch_scc1 Lnon5
    buffer_load_dword v13, off, s[16:19], 0 sc1
    s_branch Lnon4
Lnon5:
    v_mov_b32 v224, 20480
    v_mov_b32 v225, 0
    ds_write_b32 v224, v225
    ds_write_b32 v224, v13 offset:4
    ds_write_b32 v224, v225 offset:8
    s_branch Lnon3
Lpoll2_slow:
    s_mov_b32 s36, 65536
    s_add_u32 s28, s98, 2
Lpoll2:
    buffer_load_dword v9, v8, s[12:15], s101 offen sc1
    s_waitcnt vmcnt(0)
    v_subrev_u32 v9, s28, v9
    v_cmp_ge_u32 vcc, 1, v9
    s_sub_u32 s36, s36, 1
    s_cmp_eq_u64 vcc, -1
    s_cbranch_scc1 Lpoll2_ok
    s_sleep 2
    s_cmp_lg_u32 s36, 0
    s_cbranch_scc1 Lpoll2
Lpoll2_ok:
    s_branch Lpoll2_ret
Lbad:
    v_mov_b32 v9, 1
    ds_write_b32 v10, v9 offset:4
    s_branch Lbad_ret
Lslow:
    s_mov_b32 s74, 1
    s_waitcnt vmcnt(0) lgkmcnt(0)
    s_barrier
    s_mov_b32 s30, 0
    s_mov_b32 s37, 32
    v_mov_b32 v48, 0xf149f2ca
    v_mov_b32 v52, 0xf149f2ca
Lslow_max:
    buffer_load_dwordx4 v[196:199], v12, s[16:19], s30 offen offset:0
    buffer_load_dwordx4 v[200:203], v12, s[16:19], s30 offen offset:1024
    s_add_u32 s30, s30, 4096
    s_waitcnt vmcnt(0)
    v_mfma_f32_32x32x16_bf16 v[56:71], v[196:199], v[180:183], 0
    v_mfma_f32_32x32x16_bf16 v[56:71], v[200:203], v[184:187], v[56:71]
    v_mfma_f32_32x32x16_bf16 v[72:87], v[196:199], v[188:191], 0
    v_mfma_f32_32x32x16_bf16 v[72:87], v[200:203], v[192:195], v[72:87]
    s_nop 11
    v_max3_f32 v48, v48, v56, v57
    v_max3_f32 v48, v48, v58, v59
    v_max3_f32 v48, v48, v60, v61
    v_max3_f32 v48, v48, v62, v63
    v_max3_f32 v48, v48, v64, v65
    v_max3_f32 v48, v48, v66, v67
    v_max3_f32 v48, v48, v68, v69
    v_max3_f32 v48, v48, v70, v71
    v_max3_f32 v52, v52, v72, v73
    v_max3_f32 v52, v52, v74, v75
    v_max3_f32 v52, v52, v76, v77
    v_max3_f32 v52, v52, v78, v79
    v_max3_f32 v52, v52, v80, v81
    v_max3_f32 v52, v52, v82, v83
    v_max3_f32 v52, v52, v84, v85
    v_max3_f32 v52, v52, v86, v87
    s_sub_u32 s37, s37, 1
    s_cmp_lg_u32 s37, 0
    s_cbranch_scc1 Lslow_max
    v_mov_b32 v49, v48
    v_mov_b32 v53, v52
    s_nop 1
    v_permlane32_swap_b32 v48, v49
    v_permlane32_swap_b32 v52, v53
    s_nop 0
    v_max_f32 v48, v48, v49
    v_max_f32 v52, v52, v53
    ds_write_b32 v6, v48
    ds_write_b32 v6, v52 offset:256
    s_waitcnt lgkmcnt(0)
    s_barrier
    ds_read_b32 v49, v7 offset:256
    ds_read_b32 v53, v7
    s_waitcnt lgkmcnt(0)
    s_barrier
    v_max_f32 v48, v48, v49
    v_max_f32 v52, v52, v53
    v_sub_f32 v144, 0, v48
    v_sub_f32 v145, 0, v48
    v_sub_f32 v146, 0, v48
    v_sub_f32 v147, 0, v48
    v_sub_f32 v148, 0, v48
    v_sub_f32 v149, 0, v48
    v_sub_f32 v150, 0, v48
    v_sub_f32 v151, 0, v48
    v_sub_f32 v152, 0, v48
    v_sub_f32 v153, 0, v48
    v_sub_f32 v154, 0, v48
    v_sub_f32 v155, 0, v48
    v_sub_f32 v156, 0, v48
    v_sub_f32 v157, 0, v48
    v_sub_f32 v158, 0, v48
    v_sub_f32 v159, 0, v48
    v_sub_f32 v160, 0, v52
    v_sub_f32 v161, 0, v52
    v_sub_f32 v162, 0, v52
    v_sub_f32 v163, 0, v52
    v_sub_f32 v164, 0, v52
    v_sub_f32 v165, 0, v52
    v_sub_f32 v166, 0, v52
    v_sub_f32 v167, 0, v52
    v_sub_f32 v168, 0, v52
    v_sub_f32 v169, 0, v52
    v_sub_f32 v170, 0, v52
    v_sub_f32 v171, 0, v52
    v_sub_f32 v172, 0, v52
    v_sub_f32 v173, 0, v52
    v_sub_f32 v174, 0, v52
    v_sub_f32 v175, 0, v52
    v_mov_b64 v[16:17], 0
    v_mov_b64 v[18:19], 0
    v_mov_b64 v[20:21], 0
    v_mov_b64 v[22:23], 0
    v_mov_b64 v[24:25], 0
    v_mov_b64 v[26:27], 0
    v_mov_b64 v[28:29], 0
    v_mov_b64 v[30:31], 0
    v_mov_b64 v[32:33], 0
    v_mov_b64 v[34:35], 0
    v_mov_b64 v[36:37], 0
    v_mov_b64 v[38:39], 0
    v_mov_b64 v[40:41], 0
    v_mov_b64 v[42:43], 0
    v_mov_b64 v[44:45], 0
    v_mov_b64 v[46:47], 0
    v_mov_b64 v[48:49], 0
    v_mov_b64 v[50:51], 0
    v_mov_b64 v[52:53], 0
    v_mov_b64 v[54:55], 0
    v_mov_b64 v[96:97], 0
    v_mov_b64 v[98:99], 0
    v_mov_b64 v[100:101], 0
    v_mov_b64 v[102:103], 0
    v_mov_b64 v[136:137], 0
    v_mov_b64 v[138:139], 0
    v_mov_b64 v[140:141], 0
    v_mov_b64 v[142:143], 0
    s_mov_b32 s30, s40
    s_add_u32 s57, s40, 4096
    buffer_load_dwordx4 v[196:199], v12, s[16:19], s30 offen offset:0
    buffer_load_dwordx4 v[200:203], v12, s[16:19], s30 offen offset:1024
    buffer_load_dwordx4 v[220:223], v12, s[16:19], s30 offen offset:2048
    buffer_load_dwordx4 v[224:227], v12, s[16:19], s30 offen offset:3072
    buffer_load_dwordx4 v[204:207], v12, s[16:19], s57 offen offset:0
    buffer_load_dwordx4 v[208:211], v12, s[16:19], s57 offen offset:1024
    buffer_load_dwordx4 v[228:231], v12, s[16:19], s57 offen offset:2048
    buffer_load_dwordx4 v[232:235], v12, s[16:19], s57 offen offset:3072
    s_waitcnt vmcnt(6)
    v_mfma_f32_32x32x16_bf16 v[56:71], v[196:199], v[180:183], v[144:159]
    v_mfma_f32_32x32x16_bf16 v[56:71], v[200:203], v[184:187], v[56:71]
    s_mov_b32 s37, 7
    s_nop 10
    v_mfma_f32_32x32x16_bf16 v[72:87], v[196:199], v[188:191], v[160:175]
    v_exp_f32 v56, v56
    v_exp_f32 v57, v57
    v_exp_f32 v58, v58
    v_exp_f32 v59, v59
    v_cvt_pk_bf16_f32 v88, v56, v57
    v_mfma_f32_32x32x16_bf16 v[72:87], v[200:203], v[192:195], v[72:87]
    v_exp_f32 v60, v60
    v_exp_f32 v61, v61
    v_cvt_pk_bf16_f32 v89, v58, v59
    v_exp_f32 v62, v62
    v_exp_f32 v63, v63
    v_cvt_pk_bf16_f32 v90, v60, v61
    v_mfma_f32_32x32x16_bf16 v[32:47], v[136:139], v[96:99], v[32:47]
    v_exp_f32 v64, v64
    v_exp_f32 v65, v65
    v_cvt_pk_bf16_f32 v91, v62, v63
    v_exp_f32 v66, v66
    v_exp_f32 v67, v67
    v_mfma_f32_32x32x16_bf16 v[32:47], v[140:143], v[100:103], v[32:47]
    v_cvt_pk_bf16_f32 v92, v64, v65
    v_exp_f32 v68, v68
    v_exp_f32 v69, v69
    v_cvt_pk_bf16_f32 v93, v66, v67
    v_exp_f32 v70, v70
    v_smfmac_f32_16x16x64_bf16 v[52:55], v[244:247], v[96:103], v248
    s_waitcnt vmcnt(2)
    v_exp_f32 v71, v71
    v_cvt_pk_bf16_f32 v94, v68, v69
    v_cvt_pk_bf16_f32 v95, v70, v71
    v_mfma_f32_32x32x16_bf16 v[56:71], v[204:207], v[180:183], v[144:159]
    v_exp_f32 v72, v72
    v_exp_f32 v73, v73
    v_exp_f32 v74, v74
    v_exp_f32 v75, v75
    v_cvt_pk_bf16_f32 v96, v72, v73
    v_mfma_f32_32x32x16_bf16 v[56:71], v[208:211], v[184:187], v[56:71]
    v_exp_f32 v76, v76
    v_exp_f32 v77, v77
    v_cvt_pk_bf16_f32 v97, v74, v75
    v_exp_f32 v78, v78
    v_exp_f32 v79, v79
    v_cvt_pk_bf16_f32 v98, v76, v77
    v_mfma_f32_32x32x16_bf16 v[16:31], v[220:223], v[88:91], v[16:31]
    v_exp_f32 v80, v80
    v_exp_f32 v81, v81
    v_cvt_pk_bf16_f32 v99, v78, v79
    v_exp_f32 v82, v82
    v_exp_f32 v83, v83
    v_mfma_f32_32x32x16_bf16 v[16:31], v[224:227], v[92:95], v[16:31]
    v_cvt_pk_bf16_f32 v100, v80, v81
    v_exp_f32 v84, v84
    v_exp_f32 v85, v85
    v_cvt_pk_bf16_f32 v101, v82, v83
    v_exp_f32 v86, v86
    v_smfmac_f32_16x16x64_bf16 v[48:51], v[244:247], v[88:95], v248
    v_exp_f32 v87, v87
    v_cvt_pk_bf16_f32 v102, v84, v85
    v_cvt_pk_bf16_f32 v103, v86, v87
    v_mfma_f32_32x32x16_bf16 v[72:87], v[204:207], v[188:191], v[160:175]
    v_exp_f32 v56, v56
    v_exp_f32 v57, v57
    v_exp_f32 v58, v58
    v_exp_f32 v59, v59
    v_cvt_pk_bf16_f32 v88, v56, v57
    v_mfma_f32_32x32x16_bf16 v[72:87], v[208:211], v[192:195], v[72:87]
    v_exp_f32 v60, v60
    v_exp_f32 v61, v61
    v_cvt_pk_bf16_f32 v89, v58, v59
    v_exp_f32 v62, v62
    v_exp_f32 v63, v63
    v_cvt_pk_bf16_f32 v90, v60, v61
    v_mfma_f32_32x32x16_bf16 v[32:47], v[220:223], v[96:99], v[32:47]
    v_exp_f32 v64, v64
    v_exp_f32 v65, v65
    v_cvt_pk_bf16_f32 v91, v62, v63
    v_exp_f32 v66, v66
    v_exp_f32 v67, v67
    v_mfma_f32_32x32x16_bf16 v[32:47], v[224:227], v[100:103], v[32:47]
    v_cvt_pk_bf16_f32 v92, v64, v65
    v_exp_f32 v68, v68
    v_exp_f32 v69, v69
    v_cvt_pk_bf16_f32 v93, v66, v67
    v_exp_f32 v70, v70
    v_smfmac_f32_16x16x64_bf16 v[52:55], v[244:247], v[96:103], v248
    s_waitcnt vmcnt(0)
    v_exp_f32 v71, v71
    v_cvt_pk_bf16_f32 v94, v68, v69
    v_cvt_pk_bf16_f32 v95, v70, v71
    v_exp_f32 v72, v72
    v_exp_f32 v73, v73
    v_exp_f32 v74, v74
    v_exp_f32 v75, v75
    v_cvt_pk_bf16_f32 v96, v72, v73
    v_exp_f32 v76, v76
    v_exp_f32 v77, v77
    v_cvt_pk_bf16_f32 v97, v74, v75
    v_exp_f32 v78, v78
    v_exp_f32 v79, v79
    v_cvt_pk_bf16_f32 v98, v76, v77
    v_mfma_f32_32x32x16_bf16 v[16:31], v[228:231], v[88:91], v[16:31]
    v_exp_f32 v80, v80
    v_exp_f32 v81, v81
    v_cvt_pk_bf16_f32 v99, v78, v79
    v_exp_f32 v82, v82
    v_exp_f32 v83, v83
    v_mfma_f32_32x32x16_bf16 v[16:31], v[232:235], v[92:95], v[16:31]
    v_cvt_pk_bf16_f32 v100, v80, v81
    v_exp_f32 v84, v84
    v_exp_f32 v85, v85
    v_cvt_pk_bf16_f32 v101, v82, v83
    v_exp_f32 v86, v86
    v_smfmac_f32_16x16x64_bf16 v[48:51], v[244:247], v[88:95], v248
    v_exp_f32 v87, v87
    v_cvt_pk_bf16_f32 v102, v84, v85
    v_cvt_pk_bf16_f32 v103, v86, v87
    s_add_u32 s30, s57, 4096
    s_and_b32 s30, s30, 0x1ffff
    buffer_load_dwordx4 v[212:215], v12, s[16:19], s30 offen offset:0
    buffer_load_dwordx4 v[216:219], v12, s[16:19], s30 offen offset:1024
    s_add_u32 s57, s30, 4096
    s_and_b32 s57, s57, 0x1ffff
    buffer_load_dwordx4 v[120:123], v12, s[16:19], s57 offen offset:0
    buffer_load_dwordx4 v[124:127], v12, s[16:19], s57 offen offset:1024
    buffer_load_dwordx4 v[236:239], v12, s[16:19], s30 offen offset:2048
    buffer_load_dwordx4 v[240:243], v12, s[16:19], s30 offen offset:3072
    s_add_u32 s30, s57, 4096
    s_and_b32 s30, s30, 0x1ffff
    buffer_load_dwordx4 v[196:199], v12, s[16:19], s30 offen offset:0
    buffer_load_dwordx4 v[200:203], v12, s[16:19], s30 offen offset:1024
    buffer_load_dwordx4 v[136:139], v12, s[16:19], s57 offen offset:2048
    buffer_load_dwordx4 v[140:143], v12, s[16:19], s57 offen offset:3072
    s_add_u32 s57, s30, 4096
    s_and_b32 s57, s57, 0x1ffff
    buffer_load_dwordx4 v[204:207], v12, s[16:19], s57 offen offset:0
    buffer_load_dwordx4 v[208:211], v12, s[16:19], s57 offen offset:1024
    buffer_load_dwordx4 v[220:223], v12, s[16:19], s30 offen offset:2048
    buffer_load_dwordx4 v[224:227], v12, s[16:19], s30 offen offset:3072
    s_add_u32 s30, s57, 4096
    s_and_b32 s30, s30, 0x1ffff
    s_waitcnt vmcnt(12)
    v_mfma_f32_32x32x16_bf16 v[56:71], v[212:215], v[180:183], v[144:159]
    v_mfma_f32_32x32x16_bf16 v[56:71], v[216:219], v[184:187], v[56:71]
    s_nop 9
    s_branch Lslow_att_b2
.p2align 6
Lslow_att:
    v_mfma_f32_32x32x16_bf16 v[72:87], v[196:199], v[188:191], v[160:175]
    v_exp_f32 v56, v56
    v_exp_f32 v57, v57
    v_exp_f32 v58, v58
    v_exp_f32 v59, v59
    v_cvt_pk_bf16_f32 v88, v56, v57
    v_mfma_f32_32x32x16_bf16 v[72:87], v[200:203], v[192:195], v[72:87]
    buffer_load_dwordx4 v[196:199], v12, s[16:19], s30 offen offset:0
    v_exp_f32 v60, v60
    v_exp_f32 v61, v61
    v_cvt_pk_bf16_f32 v89, v58, v59
    v_exp_f32 v62, v62
    v_exp_f32 v63, v63
    v_cvt_pk_bf16_f32 v90, v60, v61
    v_mfma_f32_32x32x16_bf16 v[32:47], v[136:139], v[96:99], v[32:47]
    buffer_load_dwordx4 v[200:203], v12, s[16:19], s30 offen offset:1024
    v_exp_f32 v64, v64
    v_exp_f32 v65, v65
    v_cvt_pk_bf16_f32 v91, v62, v63
    v_exp_f32 v66, v66
    v_exp_f32 v67, v67
    v_mfma_f32_32x32x16_bf16 v[32:47], v[140:143], v[100:103], v[32:47]
    buffer_load_dwordx4 v[136:139], v12, s[16:19], s57 offen offset:2048
    v_cvt_pk_bf16_f32 v92, v64, v65
    v_exp_f32 v68, v68
    v_exp_f32 v69, v69
    v_cvt_pk_bf16_f32 v93, v66, v67
    v_exp_f32 v70, v70
    v_smfmac_f32_16x16x64_bf16 v[52:55], v[244:247], v[96:103], v248
    buffer_load_dwordx4 v[140:143], v12, s[16:19], s57 offen offset:3072
    s_waitcnt vmcnt(12)
    v_exp_f32 v71, v71
    v_cvt_pk_bf16_f32 v94, v68, v69
    v_cvt_pk_bf16_f32 v95, v70, v71
    v_mfma_f32_32x32x16_bf16 v[56:71], v[204:207], v[180:183], v[144:159]
    s_add_u32 s57, s30, 4096
    s_and_b32 s57, s57, 0x1ffff
    v_exp_f32 v72, v72
    v_exp_f32 v73, v73
    v_exp_f32 v74, v74
    v_exp_f32 v75, v75
    v_cvt_pk_bf16_f32 v96, v72, v73
    v_mfma_f32_32x32x16_bf16 v[56:71], v[208:211], v[184:187], v[56:71]
    v_exp_f32 v76, v76
    v_exp_f32 v77, v77
    v_cvt_pk_bf16_f32 v97, v74, v75
    v_exp_f32 v78, v78
    v_exp_f32 v79, v79
    v_cvt_pk_bf16_f32 v98, v76, v77
    v_mfma_f32_32x32x16_bf16 v[16:31], v[220:223], v[88:91], v[16:31]
    v_exp_f32 v80, v80
    v_exp_f32 v81, v81
    v_cvt_pk_bf16_f32 v99, v78, v79
    v_exp_f32 v82, v82
    v_exp_f32 v83, v83
    v_mfma_f32_32x32x16_bf16 v[16:31], v[224:227], v[92:95], v[16:31]
    v_cvt_pk_bf16_f32 v100, v80, v81
    v_exp_f32 v84, v84
    v_exp_f32 v85, v85
    v_cvt_pk_bf16_f32 v101, v82, v83
    v_exp_f32 v86, v86
    v_smfmac_f32_16x16x64_bf16 v[48:51], v[244:247], v[88:95], v248
    v_exp_f32 v87, v87
    v_cvt_pk_bf16_f32 v102, v84, v85
    v_cvt_pk_bf16_f32 v103, v86, v87
    v_mfma_f32_32x32x16_bf16 v[72:87], v[204:207], v[188:191], v[160:175]
    v_exp_f32 v56, v56
    v_exp_f32 v57, v57
    v_exp_f32 v58, v58
    v_exp_f32 v59, v59
    v_cvt_pk_bf16_f32 v88, v56, v57
    v_mfma_f32_32x32x16_bf16 v[72:87], v[208:211], v[192:195], v[72:87]
    buffer_load_dwordx4 v[204:207], v12, s[16:19], s57 offen offset:0
    v_exp_f32 v60, v60
    v_exp_f32 v61, v61
    v_cvt_pk_bf16_f32 v89, v58, v59
    v_exp_f32 v62, v62
    v_exp_f32 v63, v63
    v_cvt_pk_bf16_f32 v90, v60, v61
    v_mfma_f32_32x32x16_bf16 v[32:47], v[220:223], v[96:99], v[32:47]
    buffer_load_dwordx4 v[208:211], v12, s[16:19], s57 offen offset:1024
    v_exp_f32 v64, v64
    v_exp_f32 v65, v65
    v_cvt_pk_bf16_f32 v91, v62, v63
    v_exp_f32 v66, v66
    v_exp_f32 v67, v67
    v_mfma_f32_32x32x16_bf16 v[32:47], v[224:227], v[100:103], v[32:47]
    buffer_load_dwordx4 v[220:223], v12, s[16:19], s30 offen offset:2048
    v_cvt_pk_bf16_f32 v92, v64, v65
    v_exp_f32 v68, v68
    v_exp_f32 v69, v69
    v_cvt_pk_bf16_f32 v93, v66, v67
    v_exp_f32 v70, v70
    v_smfmac_f32_16x16x64_bf16 v[52:55], v[244:247], v[96:103], v248
    buffer_load_dwordx4 v[224:227], v12, s[16:19], s30 offen offset:3072
    s_waitcnt vmcnt(12)
    v_exp_f32 v71, v71
    v_cvt_pk_bf16_f32 v94, v68, v69
    v_cvt_pk_bf16_f32 v95, v70, v71
    v_mfma_f32_32x32x16_bf16 v[56:71], v[212:215], v[180:183], v[144:159]
    s_add_u32 s30, s57, 4096
    s_and_b32 s30, s30, 0x1ffff
    v_exp_f32 v72, v72
    v_exp_f32 v73, v73
    v_exp_f32 v74, v74
    v_exp_f32 v75, v75
    v_cvt_pk_bf16_f32 v96, v72, v73
    v_mfma_f32_32x32x16_bf16 v[56:71], v[216:219], v[184:187], v[56:71]
    v_exp_f32 v76, v76
    v_exp_f32 v77, v77
    v_cvt_pk_bf16_f32 v97, v74, v75
    v_exp_f32 v78, v78
    v_exp_f32 v79, v79
    v_cvt_pk_bf16_f32 v98, v76, v77
    v_mfma_f32_32x32x16_bf16 v[16:31], v[228:231], v[88:91], v[16:31]
    v_exp_f32 v80, v80
    v_exp_f32 v81, v81
    v_cvt_pk_bf16_f32 v99, v78, v79
    v_exp_f32 v82, v82
    v_exp_f32 v83, v83
    v_mfma_f32_32x32x16_bf16 v[16:31], v[232:235], v[92:95], v[16:31]
    v_cvt_pk_bf16_f32 v100, v80, v81
    v_exp_f32 v84, v84
    v_exp_f32 v85, v85
    v_cvt_pk_bf16_f32 v101, v82, v83
    v_exp_f32 v86, v86
    v_smfmac_f32_16x16x64_bf16 v[48:51], v[244:247], v[88:95], v248
    v_exp_f32 v87, v87
    v_cvt_pk_bf16_f32 v102, v84, v85
    v_cvt_pk_bf16_f32 v103, v86, v87
Lslow_att_b2:
    v_mfma_f32_32x32x16_bf16 v[72:87], v[212:215], v[188:191], v[160:175]
    v_exp_f32 v56, v56
    v_exp_f32 v57, v57
    v_exp_f32 v58, v58
    v_exp_f32 v59, v59
    v_cvt_pk_bf16_f32 v88, v56, v57
    v_mfma_f32_32x32x16_bf16 v[72:87], v[216:219], v[192:195], v[72:87]
    buffer_load_dwordx4 v[212:215], v12, s[16:19], s30 offen offset:0
    v_exp_f32 v60, v60
    v_exp_f32 v61, v61
    v_cvt_pk_bf16_f32 v89, v58, v59
    v_exp_f32 v62, v62
    v_exp_f32 v63, v63
    v_cvt_pk_bf16_f32 v90, v60, v61
    v_mfma_f32_32x32x16_bf16 v[32:47], v[228:231], v[96:99], v[32:47]
    buffer_load_dwordx4 v[216:219], v12, s[16:19], s30 offen offset:1024
    v_exp_f32 v64, v64
    v_exp_f32 v65, v65
    v_cvt_pk_bf16_f32 v91, v62, v63
    v_exp_f32 v66, v66
    v_exp_f32 v67, v67
    v_mfma_f32_32x32x16_bf16 v[32:47], v[232:235], v[100:103], v[32:47]
    buffer_load_dwordx4 v[228:231], v12, s[16:19], s57 offen offset:2048
    v_cvt_pk_bf16_f32 v92, v64, v65
    v_exp_f32 v68, v68
    v_exp_f32 v69, v69
    v_cvt_pk_bf16_f32 v93, v66, v67
    v_exp_f32 v70, v70
    v_smfmac_f32_16x16x64_bf16 v[52:55], v[244:247], v[96:103], v248
    buffer_load_dwordx4 v[232:235], v12, s[16:19], s57 offen offset:3072
    s_waitcnt vmcnt(12)
    v_exp_f32 v71, v71
    v_cvt_pk_bf16_f32 v94, v68, v69
    v_cvt_pk_bf16_f32 v95, v70, v71
    v_mfma_f32_32x32x16_bf16 v[56:71], v[120:123], v[180:183], v[144:159]
    s_add_u32 s57, s30, 4096
    s_and_b32 s57, s57, 0x1ffff
    v_exp_f32 v72, v72
    v_exp_f32 v73, v73
    v_exp_f32 v74, v74
    v_exp_f32 v75, v75
    v_cvt_pk_bf16_f32 v96, v72, v73
    v_mfma_f32_32x32x16_bf16 v[56:71], v[124:127], v[184:187], v[56:71]
    v_exp_f32 v76, v76
    v_exp_f32 v77, v77
    v_cvt_pk_bf16_f32 v97, v74, v75
    v_exp_f32 v78, v78
    v_exp_f32 v79, v79
    v_cvt_pk_bf16_f32 v98, v76, v77
    v_mfma_f32_32x32x16_bf16 v[16:31], v[236:239], v[88:91], v[16:31]
    v_exp_f32 v80, v80
    v_exp_f32 v81, v81
    v_cvt_pk_bf16_f32 v99, v78, v79
    v_exp_f32 v82, v82
    v_exp_f32 v83, v83
    v_mfma_f32_32x32x16_bf16 v[16:31], v[240:243], v[92:95], v[16:31]
    v_cvt_pk_bf16_f32 v100, v80, v81
    v_exp_f32 v84, v84
    v_exp_f32 v85, v85
    v_cvt_pk_bf16_f32 v101, v82, v83
    v_exp_f32 v86, v86
    v_smfmac_f32_16x16x64_bf16 v[48:51], v[244:247], v[88:95], v248
    v_exp_f32 v87, v87
    v_cvt_pk_bf16_f32 v102, v84, v85
    v_cvt_pk_bf16_f32 v103, v86, v87
    v_mfma_f32_32x32x16_bf16 v[72:87], v[120:123], v[188:191], v[160:175]
    v_exp_f32 v56, v56
    v_exp_f32 v57, v57
    v_exp_f32 v58, v58
    v_exp_f32 v59, v59
    v_cvt_pk_bf16_f32 v88, v56, v57
    v_mfma_f32_32x32x16_bf16 v[72:87], v[124:127], v[192:195], v[72:87]
    buffer_load_dwordx4 v[120:123], v12, s[16:19], s57 offen offset:0
    v_exp_f32 v60, v60
    v_exp_f32 v61, v61
    v_cvt_pk_bf16_f32 v89, v58, v59
    v_exp_f32 v62, v62
    v_exp_f32 v63, v63
    v_cvt_pk_bf16_f32 v90, v60, v61
    v_mfma_f32_32x32x16_bf16 v[32:47], v[236:239], v[96:99], v[32:47]
    buffer_load_dwordx4 v[124:127], v12, s[16:19], s57 offen offset:1024
    v_exp_f32 v64, v64
    v_exp_f32 v65, v65
    v_cvt_pk_bf16_f32 v91, v62, v63
    v_exp_f32 v66, v66
    v_exp_f32 v67, v67
    v_mfma_f32_32x32x16_bf16 v[32:47], v[240:243], v[100:103], v[32:47]
    buffer_load_dwordx4 v[236:239], v12, s[16:19], s30 offen offset:2048
    v_cvt_pk_bf16_f32 v92, v64, v65
    v_exp_f32 v68, v68
    v_exp_f32 v69, v69
    v_cvt_pk_bf16_f32 v93, v66, v67
    v_exp_f32 v70, v70
    v_smfmac_f32_16x16x64_bf16 v[52:55], v[244:247], v[96:103], v248
    buffer_load_dwordx4 v[240:243], v12, s[16:19], s30 offen offset:3072
    s_waitcnt vmcnt(12)
    v_exp_f32 v71, v71
    v_cvt_pk_bf16_f32 v94, v68, v69
    v_cvt_pk_bf16_f32 v95, v70, v71
    v_mfma_f32_32x32x16_bf16 v[56:71], v[196:199], v[180:183], v[144:159]
    s_add_u32 s30, s57, 4096
    s_and_b32 s30, s30, 0x1ffff
    v_exp_f32 v72, v72
    v_exp_f32 v73, v73
    v_exp_f32 v74, v74
    v_exp_f32 v75, v75
    v_cvt_pk_bf16_f32 v96, v72, v73
    v_mfma_f32_32x32x16_bf16 v[56:71], v[200:203], v[184:187], v[56:71]
    v_exp_f32 v76, v76
    v_exp_f32 v77, v77
    v_cvt_pk_bf16_f32 v97, v74, v75
    v_exp_f32 v78, v78
    v_exp_f32 v79, v79
    v_cvt_pk_bf16_f32 v98, v76, v77
    v_mfma_f32_32x32x16_bf16 v[16:31], v[136:139], v[88:91], v[16:31]
    v_exp_f32 v80, v80
    v_exp_f32 v81, v81
    v_cvt_pk_bf16_f32 v99, v78, v79
    v_exp_f32 v82, v82
    v_exp_f32 v83, v83
    v_mfma_f32_32x32x16_bf16 v[16:31], v[140:143], v[92:95], v[16:31]
    v_cvt_pk_bf16_f32 v100, v80, v81
    v_exp_f32 v84, v84
    v_exp_f32 v85, v85
    v_cvt_pk_bf16_f32 v101, v82, v83
    v_exp_f32 v86, v86
    v_smfmac_f32_16x16x64_bf16 v[48:51], v[244:247], v[88:95], v248
    v_exp_f32 v87, v87
    v_cvt_pk_bf16_f32 v102, v84, v85
    v_cvt_pk_bf16_f32 v103, v86, v87
    s_sub_u32 s37, s37, 1
    s_cmp_lg_u32 s37, 0
    s_cbranch_scc1 Lslow_att
    v_mfma_f32_32x32x16_bf16 v[72:87], v[196:199], v[188:191], v[160:175]
    v_exp_f32 v56, v56
    v_exp_f32 v57, v57
    v_exp_f32 v58, v58
    v_exp_f32 v59, v59
    v_cvt_pk_bf16_f32 v88, v56, v57
    v_mfma_f32_32x32x16_bf16 v[72:87], v[200:203], v[192:195], v[72:87]
    v_exp_f32 v60, v60
    v_exp_f32 v61, v61
    v_cvt_pk_bf16_f32 v89, v58, v59
    v_exp_f32 v62, v62
    v_exp_f32 v63, v63
    v_cvt_pk_bf16_f32 v90, v60, v61
    v_mfma_f32_32x32x16_bf16 v[32:47], v[136:139], v[96:99], v[32:47]
    v_exp_f32 v64, v64
    v_exp_f32 v65, v65
    v_cvt_pk_bf16_f32 v91, v62, v63
    v_exp_f32 v66, v66
    v_exp_f32 v67, v67
    v_mfma_f32_32x32x16_bf16 v[32:47], v[140:143], v[100:103], v[32:47]
    buffer_load_dwordx4 v[136:139], v12, s[16:19], s57 offen offset:2048
    v_cvt_pk_bf16_f32 v92, v64, v65
    v_exp_f32 v68, v68
    v_exp_f32 v69, v69
    v_cvt_pk_bf16_f32 v93, v66, v67
    v_exp_f32 v70, v70
    v_smfmac_f32_16x16x64_bf16 v[52:55], v[244:247], v[96:103], v248
    buffer_load_dwordx4 v[140:143], v12, s[16:19], s57 offen offset:3072
    s_waitcnt vmcnt(10)
    v_exp_f32 v71, v71
    v_cvt_pk_bf16_f32 v94, v68, v69
    v_cvt_pk_bf16_f32 v95, v70, v71
    v_mfma_f32_32x32x16_bf16 v[56:71], v[204:207], v[180:183], v[144:159]
    v_exp_f32 v72, v72
    v_exp_f32 v73, v73
    v_exp_f32 v74, v74
    v_exp_f32 v75, v75
    v_cvt_pk_bf16_f32 v96, v72, v73
    v_mfma_f32_32x32x16_bf16 v[56:71], v[208:211], v[184:187], v[56:71]
    v_exp_f32 v76, v76
    v_exp_f32 v77, v77
    v_cvt_pk_bf16_f32 v97, v74, v75
    v_exp_f32 v78, v78
    v_exp_f32 v79, v79
    v_cvt_pk_bf16_f32 v98, v76, v77
    v_mfma_f32_32x32x16_bf16 v[16:31], v[220:223], v[88:91], v[16:31]
    v_exp_f32 v80, v80
    v_exp_f32 v81, v81
    v_cvt_pk_bf16_f32 v99, v78, v79
    v_exp_f32 v82, v82
    v_exp_f32 v83, v83
    v_mfma_f32_32x32x16_bf16 v[16:31], v[224:227], v[92:95], v[16:31]
    v_cvt_pk_bf16_f32 v100, v80, v81
    v_exp_f32 v84, v84
    v_exp_f32 v85, v85
    v_cvt_pk_bf16_f32 v101, v82, v83
    v_exp_f32 v86, v86
    v_smfmac_f32_16x16x64_bf16 v[48:51], v[244:247], v[88:95], v248
    v_exp_f32 v87, v87
    v_cvt_pk_bf16_f32 v102, v84, v85
    v_cvt_pk_bf16_f32 v103, v86, v87
    v_mfma_f32_32x32x16_bf16 v[72:87], v[204:207], v[188:191], v[160:175]
    v_exp_f32 v56, v56
    v_exp_f32 v57, v57
    v_exp_f32 v58, v58
    v_exp_f32 v59, v59
    v_cvt_pk_bf16_f32 v88, v56, v57
    v_mfma_f32_32x32x16_bf16 v[72:87], v[208:211], v[192:195], v[72:87]
    v_exp_f32 v60, v60
    v_exp_f32 v61, v61
    v_cvt_pk_bf16_f32 v89, v58, v59
    v_exp_f32 v62, v62
    v_exp_f32 v63, v63
    v_cvt_pk_bf16_f32 v90, v60, v61
    v_mfma_f32_32x32x16_bf16 v[32:47], v[220:223], v[96:99], v[32:47]
    v_exp_f32 v64, v64
    v_exp_f32 v65, v65
    v_cvt_pk_bf16_f32 v91, v62, v63
    v_exp_f32 v66, v66
    v_exp_f32 v67, v67
    v_mfma_f32_32x32x16_bf16 v[32:47], v[224:227], v[100:103], v[32:47]
    v_cvt_pk_bf16_f32 v92, v64, v65
    v_exp_f32 v68, v68
    v_exp_f32 v69, v69
    v_cvt_pk_bf16_f32 v93, v66, v67
    v_exp_f32 v70, v70
    v_smfmac_f32_16x16x64_bf16 v[52:55], v[244:247], v[96:103], v248
    s_waitcnt vmcnt(6)
    v_exp_f32 v71, v71
    v_cvt_pk_bf16_f32 v94, v68, v69
    v_cvt_pk_bf16_f32 v95, v70, v71
    v_mfma_f32_32x32x16_bf16 v[56:71], v[212:215], v[180:183], v[144:159]
    v_exp_f32 v72, v72
    v_exp_f32 v73, v73
    v_exp_f32 v74, v74
    v_exp_f32 v75, v75
    v_cvt_pk_bf16_f32 v96, v72, v73
    v_mfma_f32_32x32x16_bf16 v[56:71], v[216:219], v[184:187], v[56:71]
    v_exp_f32 v76, v76
    v_exp_f32 v77, v77
    v_cvt_pk_bf16_f32 v97, v74, v75
    v_exp_f32 v78, v78
    v_exp_f32 v79, v79
    v_cvt_pk_bf16_f32 v98, v76, v77
    v_mfma_f32_32x32x16_bf16 v[16:31], v[228:231], v[88:91], v[16:31]
    v_exp_f32 v80, v80
    v_exp_f32 v81, v81
    v_cvt_pk_bf16_f32 v99, v78, v79
    v_exp_f32 v82, v82
    v_exp_f32 v83, v83
    v_mfma_f32_32x32x16_bf16 v[16:31], v[232:235], v[92:95], v[16:31]
    v_cvt_pk_bf16_f32 v100, v80, v81
    v_exp_f32 v84, v84
    v_exp_f32 v85, v85
    v_cvt_pk_bf16_f32 v101, v82, v83
    v_exp_f32 v86, v86
    v_smfmac_f32_16x16x64_bf16 v[48:51], v[244:247], v[88:95], v248
    v_exp_f32 v87, v87
    v_cvt_pk_bf16_f32 v102, v84, v85
    v_cvt_pk_bf16_f32 v103, v86, v87
    v_mfma_f32_32x32x16_bf16 v[72:87], v[212:215], v[188:191], v[160:175]
    v_exp_f32 v56, v56
    v_exp_f32 v57, v57
    v_exp_f32 v58, v58
    v_exp_f32 v59, v59
    v_cvt_pk_bf16_f32 v88, v56, v57
    v_mfma_f32_32x32x16_bf16 v[72:87], v[216:219], v[192:195], v[72:87]
    v_exp_f32 v60, v60
    v_exp_f32 v61, v61
    v_cvt_pk_bf16_f32 v89, v58, v59
    v_exp_f32 v62, v62
    v_exp_f32 v63, v63
    v_cvt_pk_bf16_f32 v90, v60, v61
    v_mfma_f32_32x32x16_bf16 v[32:47], v[228:231], v[96:99], v[32:47]
    v_exp_f32 v64, v64
    v_exp_f32 v65, v65
    v_cvt_pk_bf16_f32 v91, v62, v63
    v_exp_f32 v66, v66
    v_exp_f32 v67, v67
    v_mfma_f32_32x32x16_bf16 v[32:47], v[232:235], v[100:103], v[32:47]
    v_cvt_pk_bf16_f32 v92, v64, v65
    v_exp_f32 v68, v68
    v_exp_f32 v69, v69
    v_cvt_pk_bf16_f32 v93, v66, v67
    v_exp_f32 v70, v70
    v_smfmac_f32_16x16x64_bf16 v[52:55], v[244:247], v[96:103], v248
    s_waitcnt vmcnt(2)
    v_exp_f32 v71, v71
    v_cvt_pk_bf16_f32 v94, v68, v69
    v_cvt_pk_bf16_f32 v95, v70, v71
    v_mfma_f32_32x32x16_bf16 v[56:71], v[120:123], v[180:183], v[144:159]
    v_exp_f32 v72, v72
    v_exp_f32 v73, v73
    v_exp_f32 v74, v74
    v_exp_f32 v75, v75
    v_cvt_pk_bf16_f32 v96, v72, v73
    v_mfma_f32_32x32x16_bf16 v[56:71], v[124:127], v[184:187], v[56:71]
    v_exp_f32 v76, v76
    v_exp_f32 v77, v77
    v_cvt_pk_bf16_f32 v97, v74, v75
    v_exp_f32 v78, v78
    v_exp_f32 v79, v79
    v_cvt_pk_bf16_f32 v98, v76, v77
    v_mfma_f32_32x32x16_bf16 v[16:31], v[236:239], v[88:91], v[16:31]
    v_exp_f32 v80, v80
    v_exp_f32 v81, v81
    v_cvt_pk_bf16_f32 v99, v78, v79
    v_exp_f32 v82, v82
    v_exp_f32 v83, v83
    v_mfma_f32_32x32x16_bf16 v[16:31], v[240:243], v[92:95], v[16:31]
    v_cvt_pk_bf16_f32 v100, v80, v81
    v_exp_f32 v84, v84
    v_exp_f32 v85, v85
    v_cvt_pk_bf16_f32 v101, v82, v83
    v_exp_f32 v86, v86
    v_smfmac_f32_16x16x64_bf16 v[48:51], v[244:247], v[88:95], v248
    v_exp_f32 v87, v87
    v_cvt_pk_bf16_f32 v102, v84, v85
    v_cvt_pk_bf16_f32 v103, v86, v87
    v_mfma_f32_32x32x16_bf16 v[72:87], v[120:123], v[188:191], v[160:175]
    v_exp_f32 v56, v56
    v_exp_f32 v57, v57
    v_exp_f32 v58, v58
    v_exp_f32 v59, v59
    v_cvt_pk_bf16_f32 v88, v56, v57
    v_mfma_f32_32x32x16_bf16 v[72:87], v[124:127], v[192:195], v[72:87]
    v_exp_f32 v60, v60
    v_exp_f32 v61, v61
    v_cvt_pk_bf16_f32 v89, v58, v59
    v_exp_f32 v62, v62
    v_exp_f32 v63, v63
    v_cvt_pk_bf16_f32 v90, v60, v61
    v_mfma_f32_32x32x16_bf16 v[32:47], v[236:239], v[96:99], v[32:47]
    v_exp_f32 v64, v64
    v_exp_f32 v65, v65
    v_cvt_pk_bf16_f32 v91, v62, v63
    v_exp_f32 v66, v66
    v_exp_f32 v67, v67
    v_mfma_f32_32x32x16_bf16 v[32:47], v[240:243], v[100:103], v[32:47]
    v_cvt_pk_bf16_f32 v92, v64, v65
    v_exp_f32 v68, v68
    v_exp_f32 v69, v69
    v_cvt_pk_bf16_f32 v93, v66, v67
    v_exp_f32 v70, v70
    v_smfmac_f32_16x16x64_bf16 v[52:55], v[244:247], v[96:103], v248
    s_waitcnt vmcnt(0)
    v_exp_f32 v71, v71
    v_cvt_pk_bf16_f32 v94, v68, v69
    v_cvt_pk_bf16_f32 v95, v70, v71
    v_exp_f32 v72, v72
    v_exp_f32 v73, v73
    v_exp_f32 v74, v74
    v_exp_f32 v75, v75
    v_cvt_pk_bf16_f32 v96, v72, v73
    v_exp_f32 v76, v76
    v_exp_f32 v77, v77
    v_cvt_pk_bf16_f32 v97, v74, v75
    v_exp_f32 v78, v78
    v_exp_f32 v79, v79
    v_cvt_pk_bf16_f32 v98, v76, v77
    v_mfma_f32_32x32x16_bf16 v[16:31], v[136:139], v[88:91], v[16:31]
    v_exp_f32 v80, v80
    v_exp_f32 v81, v81
    v_cvt_pk_bf16_f32 v99, v78, v79
    v_exp_f32 v82, v82
    v_exp_f32 v83, v83
    v_mfma_f32_32x32x16_bf16 v[16:31], v[140:143], v[92:95], v[16:31]
    v_cvt_pk_bf16_f32 v100, v80, v81
    v_exp_f32 v84, v84
    v_exp_f32 v85, v85
    v_cvt_pk_bf16_f32 v101, v82, v83
    v_exp_f32 v86, v86
    v_smfmac_f32_16x16x64_bf16 v[48:51], v[244:247], v[88:95], v248
    v_exp_f32 v87, v87
    v_cvt_pk_bf16_f32 v102, v84, v85
    v_cvt_pk_bf16_f32 v103, v86, v87
    s_nop 1
    v_mfma_f32_32x32x16_bf16 v[32:47], v[136:139], v[96:99], v[32:47]
    v_mfma_f32_32x32x16_bf16 v[32:47], v[140:143], v[100:103], v[32:47]
    v_smfmac_f32_16x16x64_bf16 v[52:55], v[244:247], v[96:103], v248
    s_sub_u32 s50, s50, 1703936
    buffer_load_dwordx4 v[128:131], v176, s[12:15], s50 offen sc1
    buffer_load_dwordx4 v[132:135], v177, s[12:15], s50 offen sc1
    s_add_u32 s50, s50, 131072
    buffer_load_dwordx4 v[144:147], v176, s[12:15], s50 offen sc1
    buffer_load_dwordx4 v[148:151], v177, s[12:15], s50 offen sc1
    s_add_u32 s50, s50, 131072
    buffer_load_dwordx4 v[152:155], v176, s[12:15], s50 offen sc1
    buffer_load_dwordx4 v[156:159], v177, s[12:15], s50 offen sc1
    s_add_u32 s50, s50, 131072
    buffer_load_dwordx4 v[160:163], v176, s[12:15], s50 offen sc1
    buffer_load_dwordx4 v[164:167], v177, s[12:15], s50 offen sc1
    s_add_u32 s50, s50, 131072
    buffer_load_dwordx4 v[168:171], v176, s[12:15], s50 offen sc1
    buffer_load_dwordx4 v[172:175], v177, s[12:15], s50 offen sc1
    s_add_u32 s50, s50, 131072
    buffer_load_dwordx4 v[196:199], v176, s[12:15], s50 offen sc1
    buffer_load_dwordx4 v[200:203], v177, s[12:15], s50 offen sc1
    s_add_u32 s50, s50, 131072
    buffer_load_dwordx4 v[204:207], v176, s[12:15], s50 offen sc1
    buffer_load_dwordx4 v[208:211], v177, s[12:15], s50 offen sc1
    s_add_u32 s50, s50, 131072
    buffer_load_dwordx4 v[220:223], v176, s[12:15], s50 offen sc1
    buffer_load_dwordx4 v[224:227], v177, s[12:15], s50 offen sc1
    s_add_u32 s50, s50, 131072
    buffer_load_dwordx4 v[212:215], v176, s[12:15], s50 offen sc1
    buffer_load_dwordx4 v[216:219], v177, s[12:15], s50 offen sc1
    s_add_u32 s50, s50, 131072
    s_waitcnt vmcnt(0)
    s_branch Lcomb

.section .rodata,"a"
.p2align 6
.amdhsa_kernel gated_mix__softmax_full_mha__sliding_local_dilated__prompt_kernel
  .amdhsa_next_free_vgpr 256
  .amdhsa_next_free_sgpr 102
  .amdhsa_accum_offset 256
  .amdhsa_group_segment_fixed_size 0
  .amdhsa_kernarg_size 80
  .amdhsa_user_sgpr_count 2
  .amdhsa_user_sgpr_kernarg_segment_ptr 1
  .amdhsa_system_sgpr_workgroup_id_x 1
.end_amdhsa_kernel
```
